```python
import torch

def _softmax(x, axis=-1):
    return torch.softmax(x, dim=axis)
def _gelu(x):
    return torch.nn.functional.gelu(x, approximate="tanh")
def _silu(x):
    return torch.nn.functional.silu(x)
def _sigmoid(x):
    return torch.sigmoid(x)
def _layernorm(x, axis=-1, eps=1e-5):
    m = x.mean(dim=axis, keepdim=True)
    v = x.var(dim=axis, keepdim=True, unbiased=False)
    return (x - m) / torch.sqrt(v + eps)
def _scatter_add(tgt, idx, src, axis=0):
    return tgt.clone().index_add_(axis, idx, src)
def _segment_sum(src, seg, n):
    out = torch.zeros((n,) + src.shape[1:], dtype=src.dtype)
    return out.index_add_(0, seg, src)
def _pad(x, pw):
    flat = tuple(v for pair in reversed(pw) for v in pair)
    return torch.nn.functional.pad(x, flat)

kernel_name = 'standalone__mha_block_cached__near_ridge'

def setup_inputs():

    _w = (lambda a: (lambda t: t.to(torch.bfloat16) if t.is_floating_point() else t)(torch.as_tensor(a)))
    B, Sq, D = 8, 128, 512
    H, Sk, Dh = 32, 128, 128
    return {
        "x": _w((lambda *s: torch.randn(*s, dtype=torch.bfloat16) * 0.8)(B, Sq, D)),
        "k_cache": _w((lambda *s: torch.randn(*s, dtype=torch.bfloat16) * 0.8)(B, H, Sk, Dh)),
        "v_cache": _w((lambda *s: torch.randn(*s, dtype=torch.bfloat16) * 0.05)(B, H, Sk, Dh)),
        "wq": _w((lambda *s: torch.randn(*s, dtype=torch.bfloat16) * 0.8)(D, H * Dh) * (D ** -0.5)),
        "wo": _w((lambda *s: torch.randn(*s, dtype=torch.bfloat16) * 0.05)(H * Dh, D) * ((H * Dh) ** -0.5)),
    }

def reference(x, k_cache, v_cache, wq, wo):
    B, Sq, D = x.shape
    H, Dh = 32, 128
    q = (lambda x, *d: x.permute(*d))((x @ wq).reshape(B, Sq, H, Dh), 0, 2, 1, 3)
    scores = torch.einsum("bhqd,bhkd->bhqk", q, k_cache) * (Dh ** -0.5)
    p = _softmax(scores, axis=-1)
    o = torch.einsum("bhqk,bhkd->bhqd", p, v_cache)
    return (lambda x, *d: x.permute(*d))(o, 0, 2, 1, 3).reshape(B, Sq, H * Dh) @ wo
```

```asm
; @launch grid=(256,1,1) block=(384,1,1) lds=163840
.amdgcn_target "amdgcn-amd-amdhsa--gfx950"
.text
.globl standalone__mha_block_cached__near_ridge_kernel
.p2align 8
.type standalone__mha_block_cached__near_ridge_kernel,@function
standalone__mha_block_cached__near_ridge_kernel:
    s_cmp_ge_u32 s2, 256
    s_cbranch_scc1 L_end
    s_load_dwordx16 s[4:19], s[0:1], 0
    v_lshrrev_b32 v2, 6, v0
    v_and_b32 v1, 63, v0
    v_readfirstlane_b32 s25, v2
    s_nop 1
    s_cmp_lg_u32 s25, 5
    s_cbranch_scc1 L_nopf
    s_getpc_b64 s[58:59]
L_pcref:
    s_sub_u32 s58, s58, L_pcref-standalone__mha_block_cached__near_ridge_kernel
    s_subb_u32 s59, s59, 0
    s_bfe_u32 s26, s2, 0x30003
    s_lshl_b32 s26, s26, 12
    v_and_b32 v20, 31, v1
    v_lshl_add_u32 v20, v20, 7, s26
    global_load_dword v21, v20, s[58:59]
L_nopf:
    s_mov_b32 s51, s2
    s_mov_b32 s70, 0
    s_and_b32 s20, s2, 7
    s_lshr_b32 s26, s2, 3
    s_and_b32 s21, s26, 3
    s_lshr_b32 s22, s26, 2
    s_lshl2_add_u32 s23, s20, s21
    s_lshl_b32 s24, s22, 5
    s_add_u32 s24, s24, s23
    s_cmp_lt_u32 s25, 4
    s_cbranch_scc1 L_comp
    s_cmp_eq_u32 s25, 5
    s_cbranch_scc1 L_aux
    s_setprio 3
    s_sub_u32 s2, s25, 4
    v_lshrrev_b32 v2, 4, v1
    v_and_b32 v4, 7, v1
    v_xor_b32 v4, v4, v2
    v_lshlrev_b32 v4, 4, v4
    v_lshrrev_b32 v5, 3, v1
    v_lshl_add_u32 v8, v5, 10, v4
    v_xor_b32 v6, 64, v8
    v_add_u32 v9, 7168, v6
    v_add_u32 v10, 14336, v8
    v_add_u32 v11, 21504, v6
    v_lshlrev_b32 v3, 2, v2
    v_and_b32 v4, 15, v1
    v_xor_b32 v3, v3, v4
    v_lshlrev_b32 v3, 4, v3
    v_lshl_add_u32 v12, v2, 13, v3
    v_add_u32 v13, 31744, v12
    v_add_u32 v14, 63488, v12
    v_add_u32 v15, 95232, v12
    v_xor_b32 v14, 32, v14
    v_xor_b32 v15, 32, v15
    s_xor_b32 s52, s21, s22
    s_and_b32 s52, s52, 1
    s_lshl_b32 s52, s52, 2
    s_mul_i32 s57, s2, 16384
    s_lshl_b32 s53, s22, 17
    s_lshl3_add_u32 s53, s57, s53
    s_lshl_b32 s54, s23, 8
    s_lshl_b32 s26, s57, 5
    s_add_u32 s54, s54, s26
    s_waitcnt lgkmcnt(0)
    s_mov_b32 s28, s4
    s_and_b32 s29, s5, 0xffff
    s_mov_b32 s30, 1048576
    s_mov_b32 s31, 0x20000
    s_mov_b32 s32, s10
    s_and_b32 s33, s11, 0xffff
    s_mov_b32 s34, 4194304
    s_mov_b32 s35, 0x20000
    s_add_u32 s49, s52, 0
    s_and_b32 s49, s49, 7
    s_lshl_b32 s49, s49, 7
    s_add_u32 m0, s57, 0
    s_add_u32 s49, s49, s53
    buffer_load_dwordx4 v8, s[28:31], s49 offen offset:0 lds
    buffer_load_dwordx4 v9, s[28:31], s49 offen offset:1024 lds
    buffer_load_dwordx4 v10, s[28:31], s49 offen offset:2048 lds
    buffer_load_dwordx4 v11, s[28:31], s49 offen offset:3072 lds
    s_add_u32 m0, m0, 4096
    s_add_u32 s49, s49, 32768
    buffer_load_dwordx4 v8, s[28:31], s49 offen offset:0 lds
    buffer_load_dwordx4 v9, s[28:31], s49 offen offset:1024 lds
    buffer_load_dwordx4 v10, s[28:31], s49 offen offset:2048 lds
    buffer_load_dwordx4 v11, s[28:31], s49 offen offset:3072 lds
    s_add_u32 m0, m0, 4096
    s_add_u32 s49, s49, 32768
    buffer_load_dwordx4 v8, s[28:31], s49 offen offset:0 lds
    buffer_load_dwordx4 v9, s[28:31], s49 offen offset:1024 lds
    buffer_load_dwordx4 v10, s[28:31], s49 offen offset:2048 lds
    buffer_load_dwordx4 v11, s[28:31], s49 offen offset:3072 lds
    s_add_u32 m0, m0, 4096
    s_add_u32 s49, s49, 32768
    buffer_load_dwordx4 v8, s[28:31], s49 offen offset:0 lds
    buffer_load_dwordx4 v9, s[28:31], s49 offen offset:1024 lds
    buffer_load_dwordx4 v10, s[28:31], s49 offen offset:2048 lds
    buffer_load_dwordx4 v11, s[28:31], s49 offen offset:3072 lds
    s_add_u32 s49, s52, 0
    s_and_b32 s49, s49, 7
    s_lshl_b32 s49, s49, 19
    s_add_u32 m0, s57, 65536
    s_add_u32 s49, s49, s54
    buffer_load_dwordx4 v12, s[32:35], s49 offen offset:0 lds
    buffer_load_dwordx4 v13, s[32:35], s49 offen offset:1024 lds
    buffer_load_dwordx4 v14, s[32:35], s49 offen offset:2048 lds
    buffer_load_dwordx4 v15, s[32:35], s49 offen offset:3072 lds
    s_add_u32 m0, m0, 4096
    s_add_u32 s49, s49, 131072
    buffer_load_dwordx4 v12, s[32:35], s49 offen offset:0 lds
    buffer_load_dwordx4 v13, s[32:35], s49 offen offset:1024 lds
    buffer_load_dwordx4 v14, s[32:35], s49 offen offset:2048 lds
    buffer_load_dwordx4 v15, s[32:35], s49 offen offset:3072 lds
    s_add_u32 m0, m0, 4096
    s_add_u32 s49, s49, 131072
    buffer_load_dwordx4 v12, s[32:35], s49 offen offset:0 lds
    buffer_load_dwordx4 v13, s[32:35], s49 offen offset:1024 lds
    buffer_load_dwordx4 v14, s[32:35], s49 offen offset:2048 lds
    buffer_load_dwordx4 v15, s[32:35], s49 offen offset:3072 lds
    s_add_u32 m0, m0, 4096
    s_add_u32 s49, s49, 131072
    buffer_load_dwordx4 v12, s[32:35], s49 offen offset:0 lds
    buffer_load_dwordx4 v13, s[32:35], s49 offen offset:1024 lds
    buffer_load_dwordx4 v14, s[32:35], s49 offen offset:2048 lds
    buffer_load_dwordx4 v15, s[32:35], s49 offen offset:3072 lds
    s_mov_b32 s36, s6
    s_and_b32 s37, s7, 0xffff
    s_mov_b32 s38, 8388608
    s_mov_b32 s39, 0x20000
    s_mov_b32 s40, s8
    s_and_b32 s41, s9, 0xffff
    s_mov_b32 s42, 8388608
    s_mov_b32 s43, 0x20000
    s_mov_b32 s44, s12
    s_and_b32 s45, s13, 0xffff
    s_mov_b32 s46, 4194304
    s_mov_b32 s47, 0x20000
    s_lshl_b32 s55, s24, 15
    s_add_u32 s55, s55, s57
    s_lshl_b32 s56, s21, 8
    s_lshl2_add_u32 s56, s57, s56
    s_lshl_b32 s26, s20, 19
    s_add_u32 s56, s56, s26
    v_lshl_add_u32 v16, v2, 10, v3
    v_add_u32 v17, 3072, v16
    v_add_u32 v18, 6144, v16
    v_add_u32 v19, 9216, v16
    v_lshl_add_u32 v24, v2, 8, v3
    v_xor_b32 v5, v4, v2
    v_lshlrev_b32 v5, 4, v5
    v_lshl_add_u32 v20, v2, 8, v5
    v_xor_b32 v21, 64, v20
    v_xor_b32 v22, 128, v20
    v_xor_b32 v23, 192, v20
    v_xor_b32 v44, 32, v16
    v_xor_b32 v45, 32, v17
    v_xor_b32 v46, 32, v18
    v_xor_b32 v47, 32, v19
    s_add_u32 s49, s52, 1
    s_and_b32 s49, s49, 7
    s_lshl_b32 s49, s49, 7
    s_add_u32 m0, s57, 16384
    s_add_u32 s49, s49, s53
    buffer_load_dwordx4 v8, s[28:31], s49 offen offset:0 lds
    buffer_load_dwordx4 v9, s[28:31], s49 offen offset:1024 lds
    buffer_load_dwordx4 v10, s[28:31], s49 offen offset:2048 lds
    buffer_load_dwordx4 v11, s[28:31], s49 offen offset:3072 lds
    s_add_u32 m0, m0, 4096
    s_add_u32 s49, s49, 32768
    buffer_load_dwordx4 v8, s[28:31], s49 offen offset:0 lds
    buffer_load_dwordx4 v9, s[28:31], s49 offen offset:1024 lds
    buffer_load_dwordx4 v10, s[28:31], s49 offen offset:2048 lds
    buffer_load_dwordx4 v11, s[28:31], s49 offen offset:3072 lds
    s_add_u32 m0, m0, 4096
    s_add_u32 s49, s49, 32768
    buffer_load_dwordx4 v8, s[28:31], s49 offen offset:0 lds
    buffer_load_dwordx4 v9, s[28:31], s49 offen offset:1024 lds
    buffer_load_dwordx4 v10, s[28:31], s49 offen offset:2048 lds
    buffer_load_dwordx4 v11, s[28:31], s49 offen offset:3072 lds
    s_add_u32 m0, m0, 4096
    s_add_u32 s49, s49, 32768
    s_waitcnt vmcnt(40)
    buffer_load_dwordx4 v8, s[28:31], s49 offen offset:0 lds
    buffer_load_dwordx4 v9, s[28:31], s49 offen offset:1024 lds
    buffer_load_dwordx4 v10, s[28:31], s49 offen offset:2048 lds
    buffer_load_dwordx4 v11, s[28:31], s49 offen offset:3072 lds
    s_add_u32 s49, s52, 1
    s_and_b32 s49, s49, 7
    s_lshl_b32 s49, s49, 19
    s_add_u32 m0, s57, 81920
    s_add_u32 s49, s49, s54
    s_waitcnt vmcnt(40)
    buffer_load_dwordx4 v12, s[32:35], s49 offen offset:0 lds
    buffer_load_dwordx4 v13, s[32:35], s49 offen offset:1024 lds
    buffer_load_dwordx4 v14, s[32:35], s49 offen offset:2048 lds
    buffer_load_dwordx4 v15, s[32:35], s49 offen offset:3072 lds
    s_add_u32 m0, m0, 4096
    s_add_u32 s49, s49, 131072
    s_waitcnt vmcnt(40)
    buffer_load_dwordx4 v12, s[32:35], s49 offen offset:0 lds
    buffer_load_dwordx4 v13, s[32:35], s49 offen offset:1024 lds
    buffer_load_dwordx4 v14, s[32:35], s49 offen offset:2048 lds
    buffer_load_dwordx4 v15, s[32:35], s49 offen offset:3072 lds
    s_add_u32 m0, m0, 4096
    s_add_u32 s49, s49, 131072
    s_waitcnt vmcnt(40)
    buffer_load_dwordx4 v12, s[32:35], s49 offen offset:0 lds
    buffer_load_dwordx4 v13, s[32:35], s49 offen offset:1024 lds
    buffer_load_dwordx4 v14, s[32:35], s49 offen offset:2048 lds
    buffer_load_dwordx4 v15, s[32:35], s49 offen offset:3072 lds
    s_add_u32 m0, m0, 4096
    s_add_u32 s49, s49, 131072
    s_waitcnt vmcnt(40)
    buffer_load_dwordx4 v12, s[32:35], s49 offen offset:0 lds
    buffer_load_dwordx4 v13, s[32:35], s49 offen offset:1024 lds
    buffer_load_dwordx4 v14, s[32:35], s49 offen offset:2048 lds
    buffer_load_dwordx4 v15, s[32:35], s49 offen offset:3072 lds
    s_waitcnt vmcnt(32)
    s_barrier
    s_add_u32 s49, s52, 2
    s_and_b32 s49, s49, 7
    s_lshl_b32 s49, s49, 7
    s_add_u32 m0, s57, 32768
    s_add_u32 s49, s49, s53
    buffer_load_dwordx4 v8, s[28:31], s49 offen offset:0 lds
    buffer_load_dwordx4 v9, s[28:31], s49 offen offset:1024 lds
    buffer_load_dwordx4 v10, s[28:31], s49 offen offset:2048 lds
    buffer_load_dwordx4 v11, s[28:31], s49 offen offset:3072 lds
    s_add_u32 m0, m0, 4096
    s_add_u32 s49, s49, 32768
    buffer_load_dwordx4 v8, s[28:31], s49 offen offset:0 lds
    buffer_load_dwordx4 v9, s[28:31], s49 offen offset:1024 lds
    buffer_load_dwordx4 v10, s[28:31], s49 offen offset:2048 lds
    buffer_load_dwordx4 v11, s[28:31], s49 offen offset:3072 lds
    s_add_u32 m0, m0, 4096
    s_add_u32 s49, s49, 32768
    buffer_load_dwordx4 v8, s[28:31], s49 offen offset:0 lds
    buffer_load_dwordx4 v9, s[28:31], s49 offen offset:1024 lds
    buffer_load_dwordx4 v10, s[28:31], s49 offen offset:2048 lds
    buffer_load_dwordx4 v11, s[28:31], s49 offen offset:3072 lds
    s_add_u32 m0, m0, 4096
    s_add_u32 s49, s49, 32768
    s_waitcnt vmcnt(40)
    buffer_load_dwordx4 v8, s[28:31], s49 offen offset:0 lds
    buffer_load_dwordx4 v9, s[28:31], s49 offen offset:1024 lds
    buffer_load_dwordx4 v10, s[28:31], s49 offen offset:2048 lds
    buffer_load_dwordx4 v11, s[28:31], s49 offen offset:3072 lds
    s_add_u32 s49, s52, 2
    s_and_b32 s49, s49, 7
    s_lshl_b32 s49, s49, 19
    s_add_u32 m0, s57, 98304
    s_add_u32 s49, s49, s54
    s_waitcnt vmcnt(40)
    buffer_load_dwordx4 v12, s[32:35], s49 offen offset:0 lds
    buffer_load_dwordx4 v13, s[32:35], s49 offen offset:1024 lds
    buffer_load_dwordx4 v14, s[32:35], s49 offen offset:2048 lds
    buffer_load_dwordx4 v15, s[32:35], s49 offen offset:3072 lds
    s_add_u32 m0, m0, 4096
    s_add_u32 s49, s49, 131072
    s_waitcnt vmcnt(40)
    buffer_load_dwordx4 v12, s[32:35], s49 offen offset:0 lds
    buffer_load_dwordx4 v13, s[32:35], s49 offen offset:1024 lds
    buffer_load_dwordx4 v14, s[32:35], s49 offen offset:2048 lds
    buffer_load_dwordx4 v15, s[32:35], s49 offen offset:3072 lds
    s_add_u32 m0, m0, 4096
    s_add_u32 s49, s49, 131072
    s_waitcnt vmcnt(40)
    buffer_load_dwordx4 v12, s[32:35], s49 offen offset:0 lds
    buffer_load_dwordx4 v13, s[32:35], s49 offen offset:1024 lds
    buffer_load_dwordx4 v14, s[32:35], s49 offen offset:2048 lds
    buffer_load_dwordx4 v15, s[32:35], s49 offen offset:3072 lds
    s_add_u32 m0, m0, 4096
    s_add_u32 s49, s49, 131072
    s_waitcnt vmcnt(40)
    buffer_load_dwordx4 v12, s[32:35], s49 offen offset:0 lds
    buffer_load_dwordx4 v13, s[32:35], s49 offen offset:1024 lds
    buffer_load_dwordx4 v14, s[32:35], s49 offen offset:2048 lds
    buffer_load_dwordx4 v15, s[32:35], s49 offen offset:3072 lds
    s_waitcnt vmcnt(32)
    s_barrier
    s_add_u32 s49, s52, 3
    s_and_b32 s49, s49, 7
    s_lshl_b32 s49, s49, 7
    s_add_u32 m0, s57, 49152
    s_add_u32 s49, s49, s53
    buffer_load_dwordx4 v8, s[28:31], s49 offen offset:0 lds
    buffer_load_dwordx4 v9, s[28:31], s49 offen offset:1024 lds
    buffer_load_dwordx4 v10, s[28:31], s49 offen offset:2048 lds
    buffer_load_dwordx4 v11, s[28:31], s49 offen offset:3072 lds
    s_add_u32 m0, m0, 4096
    s_add_u32 s49, s49, 32768
    buffer_load_dwordx4 v8, s[28:31], s49 offen offset:0 lds
    buffer_load_dwordx4 v9, s[28:31], s49 offen offset:1024 lds
    buffer_load_dwordx4 v10, s[28:31], s49 offen offset:2048 lds
    buffer_load_dwordx4 v11, s[28:31], s49 offen offset:3072 lds
    s_add_u32 m0, m0, 4096
    s_add_u32 s49, s49, 32768
    buffer_load_dwordx4 v8, s[28:31], s49 offen offset:0 lds
    buffer_load_dwordx4 v9, s[28:31], s49 offen offset:1024 lds
    buffer_load_dwordx4 v10, s[28:31], s49 offen offset:2048 lds
    buffer_load_dwordx4 v11, s[28:31], s49 offen offset:3072 lds
    s_add_u32 m0, m0, 4096
    s_add_u32 s49, s49, 32768
    s_waitcnt vmcnt(40)
    buffer_load_dwordx4 v8, s[28:31], s49 offen offset:0 lds
    buffer_load_dwordx4 v9, s[28:31], s49 offen offset:1024 lds
    buffer_load_dwordx4 v10, s[28:31], s49 offen offset:2048 lds
    buffer_load_dwordx4 v11, s[28:31], s49 offen offset:3072 lds
    s_add_u32 s49, s52, 3
    s_and_b32 s49, s49, 7
    s_lshl_b32 s49, s49, 19
    s_add_u32 m0, s57, 114688
    s_add_u32 s49, s49, s54
    s_waitcnt vmcnt(40)
    buffer_load_dwordx4 v12, s[32:35], s49 offen offset:0 lds
    buffer_load_dwordx4 v13, s[32:35], s49 offen offset:1024 lds
    buffer_load_dwordx4 v14, s[32:35], s49 offen offset:2048 lds
    buffer_load_dwordx4 v15, s[32:35], s49 offen offset:3072 lds
    s_add_u32 m0, m0, 4096
    s_add_u32 s49, s49, 131072
    s_waitcnt vmcnt(40)
    buffer_load_dwordx4 v12, s[32:35], s49 offen offset:0 lds
    buffer_load_dwordx4 v13, s[32:35], s49 offen offset:1024 lds
    buffer_load_dwordx4 v14, s[32:35], s49 offen offset:2048 lds
    buffer_load_dwordx4 v15, s[32:35], s49 offen offset:3072 lds
    s_add_u32 m0, m0, 4096
    s_add_u32 s49, s49, 131072
    s_waitcnt vmcnt(40)
    buffer_load_dwordx4 v12, s[32:35], s49 offen offset:0 lds
    buffer_load_dwordx4 v13, s[32:35], s49 offen offset:1024 lds
    buffer_load_dwordx4 v14, s[32:35], s49 offen offset:2048 lds
    buffer_load_dwordx4 v15, s[32:35], s49 offen offset:3072 lds
    s_add_u32 m0, m0, 4096
    s_add_u32 s49, s49, 131072
    s_waitcnt vmcnt(40)
    buffer_load_dwordx4 v12, s[32:35], s49 offen offset:0 lds
    buffer_load_dwordx4 v13, s[32:35], s49 offen offset:1024 lds
    buffer_load_dwordx4 v14, s[32:35], s49 offen offset:2048 lds
    buffer_load_dwordx4 v15, s[32:35], s49 offen offset:3072 lds
    s_waitcnt vmcnt(32)
    s_barrier
    s_add_u32 m0, s57, 131072
    s_add_u32 s49, s55, 0
    buffer_load_dwordx4 v20, s[36:39], s49 offen offset:0 nt lds
    buffer_load_dwordx4 v21, s[36:39], s49 offen offset:1024 nt lds
    buffer_load_dwordx4 v22, s[36:39], s49 offen offset:2048 nt lds
    buffer_load_dwordx4 v23, s[36:39], s49 offen offset:3072 nt lds
    s_add_u32 m0, m0, 4096
    s_add_u32 s49, s49, 4096
    buffer_load_dwordx4 v20, s[36:39], s49 offen offset:0 nt lds
    buffer_load_dwordx4 v21, s[36:39], s49 offen offset:1024 nt lds
    buffer_load_dwordx4 v22, s[36:39], s49 offen offset:2048 nt lds
    buffer_load_dwordx4 v23, s[36:39], s49 offen offset:3072 nt lds
    s_add_u32 m0, m0, 4096
    s_add_u32 s49, s49, 4096
    buffer_load_dwordx4 v20, s[36:39], s49 offen offset:0 nt lds
    buffer_load_dwordx4 v21, s[36:39], s49 offen offset:1024 nt lds
    buffer_load_dwordx4 v22, s[36:39], s49 offen offset:2048 nt lds
    buffer_load_dwordx4 v23, s[36:39], s49 offen offset:3072 nt lds
    s_add_u32 m0, m0, 4096
    s_add_u32 s49, s49, 4096
    s_waitcnt vmcnt(40)
    buffer_load_dwordx4 v20, s[36:39], s49 offen offset:0 nt lds
    buffer_load_dwordx4 v21, s[36:39], s49 offen offset:1024 nt lds
    buffer_load_dwordx4 v22, s[36:39], s49 offen offset:2048 nt lds
    buffer_load_dwordx4 v23, s[36:39], s49 offen offset:3072 nt lds
    s_add_u32 s49, s52, 4
    s_and_b32 s49, s49, 7
    s_lshl_b32 s49, s49, 7
    s_add_u32 m0, s57, 0
    s_add_u32 s49, s49, s53
    s_waitcnt vmcnt(40)
    buffer_load_dwordx4 v8, s[28:31], s49 offen offset:0 lds
    buffer_load_dwordx4 v9, s[28:31], s49 offen offset:1024 lds
    buffer_load_dwordx4 v10, s[28:31], s49 offen offset:2048 lds
    buffer_load_dwordx4 v11, s[28:31], s49 offen offset:3072 lds
    s_add_u32 m0, m0, 4096
    s_add_u32 s49, s49, 32768
    s_waitcnt vmcnt(40)
    buffer_load_dwordx4 v8, s[28:31], s49 offen offset:0 lds
    buffer_load_dwordx4 v9, s[28:31], s49 offen offset:1024 lds
    buffer_load_dwordx4 v10, s[28:31], s49 offen offset:2048 lds
    buffer_load_dwordx4 v11, s[28:31], s49 offen offset:3072 lds
    s_add_u32 m0, m0, 4096
    s_add_u32 s49, s49, 32768
    s_waitcnt vmcnt(40)
    buffer_load_dwordx4 v8, s[28:31], s49 offen offset:0 lds
    buffer_load_dwordx4 v9, s[28:31], s49 offen offset:1024 lds
    buffer_load_dwordx4 v10, s[28:31], s49 offen offset:2048 lds
    buffer_load_dwordx4 v11, s[28:31], s49 offen offset:3072 lds
    s_add_u32 m0, m0, 4096
    s_add_u32 s49, s49, 32768
    s_waitcnt vmcnt(40)
    buffer_load_dwordx4 v8, s[28:31], s49 offen offset:0 lds
    buffer_load_dwordx4 v9, s[28:31], s49 offen offset:1024 lds
    buffer_load_dwordx4 v10, s[28:31], s49 offen offset:2048 lds
    buffer_load_dwordx4 v11, s[28:31], s49 offen offset:3072 lds
    s_add_u32 s49, s52, 4
    s_and_b32 s49, s49, 7
    s_lshl_b32 s49, s49, 19
    s_add_u32 m0, s57, 65536
    s_add_u32 s49, s49, s54
    s_waitcnt vmcnt(40)
    buffer_load_dwordx4 v12, s[32:35], s49 offen offset:0 lds
    buffer_load_dwordx4 v13, s[32:35], s49 offen offset:1024 lds
    buffer_load_dwordx4 v14, s[32:35], s49 offen offset:2048 lds
    buffer_load_dwordx4 v15, s[32:35], s49 offen offset:3072 lds
    s_add_u32 m0, m0, 4096
    s_add_u32 s49, s49, 131072
    s_waitcnt vmcnt(40)
    buffer_load_dwordx4 v12, s[32:35], s49 offen offset:0 lds
    buffer_load_dwordx4 v13, s[32:35], s49 offen offset:1024 lds
    buffer_load_dwordx4 v14, s[32:35], s49 offen offset:2048 lds
    buffer_load_dwordx4 v15, s[32:35], s49 offen offset:3072 lds
    s_add_u32 m0, m0, 4096
    s_add_u32 s49, s49, 131072
    s_waitcnt vmcnt(40)
    buffer_load_dwordx4 v12, s[32:35], s49 offen offset:0 lds
    buffer_load_dwordx4 v13, s[32:35], s49 offen offset:1024 lds
    buffer_load_dwordx4 v14, s[32:35], s49 offen offset:2048 lds
    buffer_load_dwordx4 v15, s[32:35], s49 offen offset:3072 lds
    s_add_u32 m0, m0, 4096
    s_add_u32 s49, s49, 131072
    s_waitcnt vmcnt(40)
    buffer_load_dwordx4 v12, s[32:35], s49 offen offset:0 lds
    buffer_load_dwordx4 v13, s[32:35], s49 offen offset:1024 lds
    buffer_load_dwordx4 v14, s[32:35], s49 offen offset:2048 lds
    buffer_load_dwordx4 v15, s[32:35], s49 offen offset:3072 lds
    s_barrier
    s_add_u32 s49, s52, 5
    s_and_b32 s49, s49, 7
    s_lshl_b32 s49, s49, 7
    s_add_u32 m0, s57, 16384
    s_add_u32 s49, s49, s53
    s_waitcnt vmcnt(40)
    buffer_load_dwordx4 v8, s[28:31], s49 offen offset:0 lds
    buffer_load_dwordx4 v9, s[28:31], s49 offen offset:1024 lds
    buffer_load_dwordx4 v10, s[28:31], s49 offen offset:2048 lds
    buffer_load_dwordx4 v11, s[28:31], s49 offen offset:3072 lds
    s_add_u32 m0, m0, 4096
    s_add_u32 s49, s49, 32768
    s_waitcnt vmcnt(40)
    buffer_load_dwordx4 v8, s[28:31], s49 offen offset:0 lds
    buffer_load_dwordx4 v9, s[28:31], s49 offen offset:1024 lds
    buffer_load_dwordx4 v10, s[28:31], s49 offen offset:2048 lds
    buffer_load_dwordx4 v11, s[28:31], s49 offen offset:3072 lds
    s_add_u32 m0, m0, 4096
    s_add_u32 s49, s49, 32768
    s_waitcnt vmcnt(40)
    buffer_load_dwordx4 v8, s[28:31], s49 offen offset:0 lds
    buffer_load_dwordx4 v9, s[28:31], s49 offen offset:1024 lds
    buffer_load_dwordx4 v10, s[28:31], s49 offen offset:2048 lds
    buffer_load_dwordx4 v11, s[28:31], s49 offen offset:3072 lds
    s_add_u32 m0, m0, 4096
    s_add_u32 s49, s49, 32768
    s_waitcnt vmcnt(40)
    buffer_load_dwordx4 v8, s[28:31], s49 offen offset:0 lds
    buffer_load_dwordx4 v9, s[28:31], s49 offen offset:1024 lds
    buffer_load_dwordx4 v10, s[28:31], s49 offen offset:2048 lds
    buffer_load_dwordx4 v11, s[28:31], s49 offen offset:3072 lds
    s_add_u32 s49, s52, 5
    s_and_b32 s49, s49, 7
    s_lshl_b32 s49, s49, 19
    s_add_u32 m0, s57, 81920
    s_add_u32 s49, s49, s54
    s_waitcnt vmcnt(40)
    buffer_load_dwordx4 v12, s[32:35], s49 offen offset:0 lds
    buffer_load_dwordx4 v13, s[32:35], s49 offen offset:1024 lds
    buffer_load_dwordx4 v14, s[32:35], s49 offen offset:2048 lds
    buffer_load_dwordx4 v15, s[32:35], s49 offen offset:3072 lds
    s_add_u32 m0, m0, 4096
    s_add_u32 s49, s49, 131072
    s_waitcnt vmcnt(40)
    buffer_load_dwordx4 v12, s[32:35], s49 offen offset:0 lds
    buffer_load_dwordx4 v13, s[32:35], s49 offen offset:1024 lds
    buffer_load_dwordx4 v14, s[32:35], s49 offen offset:2048 lds
    buffer_load_dwordx4 v15, s[32:35], s49 offen offset:3072 lds
    s_add_u32 m0, m0, 4096
    s_add_u32 s49, s49, 131072
    s_waitcnt vmcnt(40)
    buffer_load_dwordx4 v12, s[32:35], s49 offen offset:0 lds
    buffer_load_dwordx4 v13, s[32:35], s49 offen offset:1024 lds
    buffer_load_dwordx4 v14, s[32:35], s49 offen offset:2048 lds
    buffer_load_dwordx4 v15, s[32:35], s49 offen offset:3072 lds
    s_add_u32 m0, m0, 4096
    s_add_u32 s49, s49, 131072
    s_waitcnt vmcnt(40)
    buffer_load_dwordx4 v12, s[32:35], s49 offen offset:0 lds
    buffer_load_dwordx4 v13, s[32:35], s49 offen offset:1024 lds
    buffer_load_dwordx4 v14, s[32:35], s49 offen offset:2048 lds
    buffer_load_dwordx4 v15, s[32:35], s49 offen offset:3072 lds
    s_waitcnt vmcnt(32)
    s_barrier
    s_add_u32 m0, s57, 147456
    s_add_u32 s49, s55, 16384
    buffer_load_dwordx4 v20, s[36:39], s49 offen offset:0 nt lds
    buffer_load_dwordx4 v21, s[36:39], s49 offen offset:1024 nt lds
    buffer_load_dwordx4 v22, s[36:39], s49 offen offset:2048 nt lds
    buffer_load_dwordx4 v23, s[36:39], s49 offen offset:3072 nt lds
    s_add_u32 m0, m0, 4096
    s_add_u32 s49, s49, 4096
    buffer_load_dwordx4 v20, s[36:39], s49 offen offset:0 nt lds
    buffer_load_dwordx4 v21, s[36:39], s49 offen offset:1024 nt lds
    buffer_load_dwordx4 v22, s[36:39], s49 offen offset:2048 nt lds
    buffer_load_dwordx4 v23, s[36:39], s49 offen offset:3072 nt lds
    s_add_u32 m0, m0, 4096
    s_add_u32 s49, s49, 4096
    buffer_load_dwordx4 v20, s[36:39], s49 offen offset:0 nt lds
    buffer_load_dwordx4 v21, s[36:39], s49 offen offset:1024 nt lds
    buffer_load_dwordx4 v22, s[36:39], s49 offen offset:2048 nt lds
    buffer_load_dwordx4 v23, s[36:39], s49 offen offset:3072 nt lds
    s_add_u32 m0, m0, 4096
    s_add_u32 s49, s49, 4096
    s_waitcnt vmcnt(40)
    buffer_load_dwordx4 v20, s[36:39], s49 offen offset:0 nt lds
    buffer_load_dwordx4 v21, s[36:39], s49 offen offset:1024 nt lds
    buffer_load_dwordx4 v22, s[36:39], s49 offen offset:2048 nt lds
    buffer_load_dwordx4 v23, s[36:39], s49 offen offset:3072 nt lds
    s_add_u32 s49, s52, 6
    s_and_b32 s49, s49, 7
    s_lshl_b32 s49, s49, 7
    s_add_u32 m0, s57, 32768
    s_add_u32 s49, s49, s53
    s_waitcnt vmcnt(40)
    buffer_load_dwordx4 v8, s[28:31], s49 offen offset:0 lds
    buffer_load_dwordx4 v9, s[28:31], s49 offen offset:1024 lds
    buffer_load_dwordx4 v10, s[28:31], s49 offen offset:2048 lds
    buffer_load_dwordx4 v11, s[28:31], s49 offen offset:3072 lds
    s_add_u32 m0, m0, 4096
    s_add_u32 s49, s49, 32768
    s_waitcnt vmcnt(40)
    buffer_load_dwordx4 v8, s[28:31], s49 offen offset:0 lds
    buffer_load_dwordx4 v9, s[28:31], s49 offen offset:1024 lds
    buffer_load_dwordx4 v10, s[28:31], s49 offen offset:2048 lds
    buffer_load_dwordx4 v11, s[28:31], s49 offen offset:3072 lds
    s_add_u32 m0, m0, 4096
    s_add_u32 s49, s49, 32768
    s_waitcnt vmcnt(40)
    buffer_load_dwordx4 v8, s[28:31], s49 offen offset:0 lds
    buffer_load_dwordx4 v9, s[28:31], s49 offen offset:1024 lds
    buffer_load_dwordx4 v10, s[28:31], s49 offen offset:2048 lds
    buffer_load_dwordx4 v11, s[28:31], s49 offen offset:3072 lds
    s_add_u32 m0, m0, 4096
    s_add_u32 s49, s49, 32768
    s_waitcnt vmcnt(40)
    buffer_load_dwordx4 v8, s[28:31], s49 offen offset:0 lds
    buffer_load_dwordx4 v9, s[28:31], s49 offen offset:1024 lds
    buffer_load_dwordx4 v10, s[28:31], s49 offen offset:2048 lds
    buffer_load_dwordx4 v11, s[28:31], s49 offen offset:3072 lds
    s_add_u32 s49, s52, 6
    s_and_b32 s49, s49, 7
    s_lshl_b32 s49, s49, 19
    s_add_u32 m0, s57, 98304
    s_add_u32 s49, s49, s54
    s_waitcnt vmcnt(40)
    buffer_load_dwordx4 v12, s[32:35], s49 offen offset:0 lds
    buffer_load_dwordx4 v13, s[32:35], s49 offen offset:1024 lds
    buffer_load_dwordx4 v14, s[32:35], s49 offen offset:2048 lds
    buffer_load_dwordx4 v15, s[32:35], s49 offen offset:3072 lds
    s_add_u32 m0, m0, 4096
    s_add_u32 s49, s49, 131072
    s_waitcnt vmcnt(40)
    buffer_load_dwordx4 v12, s[32:35], s49 offen offset:0 lds
    buffer_load_dwordx4 v13, s[32:35], s49 offen offset:1024 lds
    buffer_load_dwordx4 v14, s[32:35], s49 offen offset:2048 lds
    buffer_load_dwordx4 v15, s[32:35], s49 offen offset:3072 lds
    s_add_u32 m0, m0, 4096
    s_add_u32 s49, s49, 131072
    s_waitcnt vmcnt(40)
    buffer_load_dwordx4 v12, s[32:35], s49 offen offset:0 lds
    buffer_load_dwordx4 v13, s[32:35], s49 offen offset:1024 lds
    buffer_load_dwordx4 v14, s[32:35], s49 offen offset:2048 lds
    buffer_load_dwordx4 v15, s[32:35], s49 offen offset:3072 lds
    s_add_u32 m0, m0, 4096
    s_add_u32 s49, s49, 131072
    s_waitcnt vmcnt(40)
    buffer_load_dwordx4 v12, s[32:35], s49 offen offset:0 lds
    buffer_load_dwordx4 v13, s[32:35], s49 offen offset:1024 lds
    buffer_load_dwordx4 v14, s[32:35], s49 offen offset:2048 lds
    buffer_load_dwordx4 v15, s[32:35], s49 offen offset:3072 lds
    s_barrier
    s_add_u32 s49, s52, 7
    s_and_b32 s49, s49, 7
    s_lshl_b32 s49, s49, 7
    s_add_u32 m0, s57, 49152
    s_add_u32 s49, s49, s53
    s_waitcnt vmcnt(40)
    buffer_load_dwordx4 v8, s[28:31], s49 offen offset:0 lds
    buffer_load_dwordx4 v9, s[28:31], s49 offen offset:1024 lds
    buffer_load_dwordx4 v10, s[28:31], s49 offen offset:2048 lds
    buffer_load_dwordx4 v11, s[28:31], s49 offen offset:3072 lds
    s_add_u32 m0, m0, 4096
    s_add_u32 s49, s49, 32768
    s_waitcnt vmcnt(40)
    buffer_load_dwordx4 v8, s[28:31], s49 offen offset:0 lds
    buffer_load_dwordx4 v9, s[28:31], s49 offen offset:1024 lds
    buffer_load_dwordx4 v10, s[28:31], s49 offen offset:2048 lds
    buffer_load_dwordx4 v11, s[28:31], s49 offen offset:3072 lds
    s_add_u32 m0, m0, 4096
    s_add_u32 s49, s49, 32768
    s_waitcnt vmcnt(40)
    buffer_load_dwordx4 v8, s[28:31], s49 offen offset:0 lds
    buffer_load_dwordx4 v9, s[28:31], s49 offen offset:1024 lds
    buffer_load_dwordx4 v10, s[28:31], s49 offen offset:2048 lds
    buffer_load_dwordx4 v11, s[28:31], s49 offen offset:3072 lds
    s_add_u32 m0, m0, 4096
    s_add_u32 s49, s49, 32768
    s_waitcnt vmcnt(40)
    buffer_load_dwordx4 v8, s[28:31], s49 offen offset:0 lds
    buffer_load_dwordx4 v9, s[28:31], s49 offen offset:1024 lds
    buffer_load_dwordx4 v10, s[28:31], s49 offen offset:2048 lds
    buffer_load_dwordx4 v11, s[28:31], s49 offen offset:3072 lds
    s_add_u32 s49, s52, 7
    s_and_b32 s49, s49, 7
    s_lshl_b32 s49, s49, 19
    s_add_u32 m0, s57, 114688
    s_add_u32 s49, s49, s54
    s_waitcnt vmcnt(40)
    buffer_load_dwordx4 v12, s[32:35], s49 offen offset:0 lds
    buffer_load_dwordx4 v13, s[32:35], s49 offen offset:1024 lds
    buffer_load_dwordx4 v14, s[32:35], s49 offen offset:2048 lds
    buffer_load_dwordx4 v15, s[32:35], s49 offen offset:3072 lds
    s_add_u32 m0, m0, 4096
    s_add_u32 s49, s49, 131072
    s_waitcnt vmcnt(40)
    buffer_load_dwordx4 v12, s[32:35], s49 offen offset:0 lds
    buffer_load_dwordx4 v13, s[32:35], s49 offen offset:1024 lds
    buffer_load_dwordx4 v14, s[32:35], s49 offen offset:2048 lds
    buffer_load_dwordx4 v15, s[32:35], s49 offen offset:3072 lds
    s_add_u32 m0, m0, 4096
    s_add_u32 s49, s49, 131072
    s_waitcnt vmcnt(40)
    buffer_load_dwordx4 v12, s[32:35], s49 offen offset:0 lds
    buffer_load_dwordx4 v13, s[32:35], s49 offen offset:1024 lds
    buffer_load_dwordx4 v14, s[32:35], s49 offen offset:2048 lds
    buffer_load_dwordx4 v15, s[32:35], s49 offen offset:3072 lds
    s_add_u32 m0, m0, 4096
    s_add_u32 s49, s49, 131072
    s_waitcnt vmcnt(40)
    buffer_load_dwordx4 v12, s[32:35], s49 offen offset:0 lds
    buffer_load_dwordx4 v13, s[32:35], s49 offen offset:1024 lds
    buffer_load_dwordx4 v14, s[32:35], s49 offen offset:2048 lds
    buffer_load_dwordx4 v15, s[32:35], s49 offen offset:3072 lds
    v_lshlrev_b32 v30, 7, v1
    s_lshr_b32 s26, s51, 3
    s_lshl_b32 s26, s26, 14
    s_lshl_b32 s27, s20, 19
    s_add_u32 s26, s26, s27
    buffer_load_dword v31, v30, s[44:47], s26 offen
    s_add_u32 s26, s26, 8192
    buffer_load_dword v32, v30, s[44:47], s26 offen
    s_waitcnt vmcnt(34)
    s_barrier
    s_add_u32 m0, s57, 0
    s_add_u32 s49, s55, 0
    buffer_load_dwordx4 v24, s[40:43], s49 offen offset:0 nt lds
    buffer_load_dwordx4 v24, s[40:43], s49 offen offset:1024 nt lds
    buffer_load_dwordx4 v24, s[40:43], s49 offen offset:2048 nt lds
    buffer_load_dwordx4 v24, s[40:43], s49 offen offset:3072 nt lds
    s_add_u32 m0, m0, 4096
    s_add_u32 s49, s49, 4096
    buffer_load_dwordx4 v24, s[40:43], s49 offen offset:0 nt lds
    buffer_load_dwordx4 v24, s[40:43], s49 offen offset:1024 nt lds
    buffer_load_dwordx4 v24, s[40:43], s49 offen offset:2048 nt lds
    buffer_load_dwordx4 v24, s[40:43], s49 offen offset:3072 nt lds
    s_add_u32 m0, m0, 4096
    s_add_u32 s49, s49, 4096
    s_waitcnt vmcnt(40)
    buffer_load_dwordx4 v24, s[40:43], s49 offen offset:0 nt lds
    buffer_load_dwordx4 v24, s[40:43], s49 offen offset:1024 nt lds
    buffer_load_dwordx4 v24, s[40:43], s49 offen offset:2048 nt lds
    buffer_load_dwordx4 v24, s[40:43], s49 offen offset:3072 nt lds
    s_add_u32 m0, m0, 4096
    s_add_u32 s49, s49, 4096
    s_waitcnt vmcnt(40)
    buffer_load_dwordx4 v24, s[40:43], s49 offen offset:0 nt lds
    buffer_load_dwordx4 v24, s[40:43], s49 offen offset:1024 nt lds
    buffer_load_dwordx4 v24, s[40:43], s49 offen offset:2048 nt lds
    buffer_load_dwordx4 v24, s[40:43], s49 offen offset:3072 nt lds
    s_add_u32 m0, s57, 16384
    s_add_u32 s49, s55, 16384
    s_waitcnt vmcnt(40)
    buffer_load_dwordx4 v24, s[40:43], s49 offen offset:0 nt lds
    buffer_load_dwordx4 v24, s[40:43], s49 offen offset:1024 nt lds
    buffer_load_dwordx4 v24, s[40:43], s49 offen offset:2048 nt lds
    buffer_load_dwordx4 v24, s[40:43], s49 offen offset:3072 nt lds
    s_add_u32 m0, m0, 4096
    s_add_u32 s49, s49, 4096
    s_waitcnt vmcnt(40)
    buffer_load_dwordx4 v24, s[40:43], s49 offen offset:0 nt lds
    buffer_load_dwordx4 v24, s[40:43], s49 offen offset:1024 nt lds
    buffer_load_dwordx4 v24, s[40:43], s49 offen offset:2048 nt lds
    buffer_load_dwordx4 v24, s[40:43], s49 offen offset:3072 nt lds
    s_add_u32 m0, m0, 4096
    s_add_u32 s49, s49, 4096
    s_waitcnt vmcnt(40)
    buffer_load_dwordx4 v24, s[40:43], s49 offen offset:0 nt lds
    buffer_load_dwordx4 v24, s[40:43], s49 offen offset:1024 nt lds
    buffer_load_dwordx4 v24, s[40:43], s49 offen offset:2048 nt lds
    buffer_load_dwordx4 v24, s[40:43], s49 offen offset:3072 nt lds
    s_add_u32 m0, m0, 4096
    s_add_u32 s49, s49, 4096
    s_waitcnt vmcnt(40)
    buffer_load_dwordx4 v24, s[40:43], s49 offen offset:0 nt lds
    buffer_load_dwordx4 v24, s[40:43], s49 offen offset:1024 nt lds
    buffer_load_dwordx4 v24, s[40:43], s49 offen offset:2048 nt lds
    buffer_load_dwordx4 v24, s[40:43], s49 offen offset:3072 nt lds
    s_waitcnt vmcnt(34)
    s_barrier
    s_barrier
    s_add_u32 s26, s21, 0
    s_and_b32 s26, s26, 3
    s_lshl_b32 s26, s26, 17
    s_add_u32 m0, s57, 65536
    s_add_u32 s49, s56, s26
    buffer_load_dwordx4 v16, s[44:47], s49 offen offset:0 lds
    buffer_load_dwordx4 v17, s[44:47], s49 offen offset:1024 lds
    buffer_load_dwordx4 v18, s[44:47], s49 offen offset:2048 lds
    buffer_load_dwordx4 v19, s[44:47], s49 offen offset:3072 lds
    s_add_u32 m0, m0, 4096
    s_add_u32 s49, s49, 16384
    buffer_load_dwordx4 v44, s[44:47], s49 offen offset:0 lds
    buffer_load_dwordx4 v45, s[44:47], s49 offen offset:1024 lds
    buffer_load_dwordx4 v46, s[44:47], s49 offen offset:2048 lds
    buffer_load_dwordx4 v47, s[44:47], s49 offen offset:3072 lds
    s_add_u32 m0, m0, 4096
    s_add_u32 s49, s49, 16384
    s_waitcnt vmcnt(40)
    buffer_load_dwordx4 v16, s[44:47], s49 offen offset:0 lds
    buffer_load_dwordx4 v17, s[44:47], s49 offen offset:1024 lds
    buffer_load_dwordx4 v18, s[44:47], s49 offen offset:2048 lds
    buffer_load_dwordx4 v19, s[44:47], s49 offen offset:3072 lds
    s_add_u32 m0, m0, 4096
    s_add_u32 s49, s49, 16384
    s_waitcnt vmcnt(40)
    buffer_load_dwordx4 v44, s[44:47], s49 offen offset:0 lds
    buffer_load_dwordx4 v45, s[44:47], s49 offen offset:1024 lds
    buffer_load_dwordx4 v46, s[44:47], s49 offen offset:2048 lds
    buffer_load_dwordx4 v47, s[44:47], s49 offen offset:3072 lds
    s_add_u32 s26, s21, 0
    s_and_b32 s26, s26, 3
    s_lshl_b32 s26, s26, 17
    s_add_u32 s26, s26, 65536
    s_add_u32 m0, s57, 81920
    s_add_u32 s49, s56, s26
    s_waitcnt vmcnt(40)
    buffer_load_dwordx4 v16, s[44:47], s49 offen offset:0 lds
    buffer_load_dwordx4 v17, s[44:47], s49 offen offset:1024 lds
    buffer_load_dwordx4 v18, s[44:47], s49 offen offset:2048 lds
    buffer_load_dwordx4 v19, s[44:47], s49 offen offset:3072 lds
    s_add_u32 m0, m0, 4096
    s_add_u32 s49, s49, 16384
    s_waitcnt vmcnt(40)
    buffer_load_dwordx4 v44, s[44:47], s49 offen offset:0 lds
    buffer_load_dwordx4 v45, s[44:47], s49 offen offset:1024 lds
    buffer_load_dwordx4 v46, s[44:47], s49 offen offset:2048 lds
    buffer_load_dwordx4 v47, s[44:47], s49 offen offset:3072 lds
    s_add_u32 m0, m0, 4096
    s_add_u32 s49, s49, 16384
    s_waitcnt vmcnt(40)
    buffer_load_dwordx4 v16, s[44:47], s49 offen offset:0 lds
    buffer_load_dwordx4 v17, s[44:47], s49 offen offset:1024 lds
    buffer_load_dwordx4 v18, s[44:47], s49 offen offset:2048 lds
    buffer_load_dwordx4 v19, s[44:47], s49 offen offset:3072 lds
    s_add_u32 m0, m0, 4096
    s_add_u32 s49, s49, 16384
    s_waitcnt vmcnt(40)
    buffer_load_dwordx4 v44, s[44:47], s49 offen offset:0 lds
    buffer_load_dwordx4 v45, s[44:47], s49 offen offset:1024 lds
    buffer_load_dwordx4 v46, s[44:47], s49 offen offset:2048 lds
    buffer_load_dwordx4 v47, s[44:47], s49 offen offset:3072 lds
    s_add_u32 s26, s21, 1
    s_and_b32 s26, s26, 3
    s_lshl_b32 s26, s26, 17
    s_add_u32 m0, s57, 32768
    s_add_u32 s49, s56, s26
    s_waitcnt vmcnt(40)
    buffer_load_dwordx4 v16, s[44:47], s49 offen offset:0 lds
    buffer_load_dwordx4 v17, s[44:47], s49 offen offset:1024 lds
    buffer_load_dwordx4 v18, s[44:47], s49 offen offset:2048 lds
    buffer_load_dwordx4 v19, s[44:47], s49 offen offset:3072 lds
    s_add_u32 m0, m0, 4096
    s_add_u32 s49, s49, 16384
    s_waitcnt vmcnt(40)
    buffer_load_dwordx4 v44, s[44:47], s49 offen offset:0 lds
    buffer_load_dwordx4 v45, s[44:47], s49 offen offset:1024 lds
    buffer_load_dwordx4 v46, s[44:47], s49 offen offset:2048 lds
    buffer_load_dwordx4 v47, s[44:47], s49 offen offset:3072 lds
    s_add_u32 m0, m0, 4096
    s_add_u32 s49, s49, 16384
    s_waitcnt vmcnt(40)
    buffer_load_dwordx4 v16, s[44:47], s49 offen offset:0 lds
    buffer_load_dwordx4 v17, s[44:47], s49 offen offset:1024 lds
    buffer_load_dwordx4 v18, s[44:47], s49 offen offset:2048 lds
    buffer_load_dwordx4 v19, s[44:47], s49 offen offset:3072 lds
    s_add_u32 m0, m0, 4096
    s_add_u32 s49, s49, 16384
    s_waitcnt vmcnt(40)
    buffer_load_dwordx4 v44, s[44:47], s49 offen offset:0 lds
    buffer_load_dwordx4 v45, s[44:47], s49 offen offset:1024 lds
    buffer_load_dwordx4 v46, s[44:47], s49 offen offset:2048 lds
    buffer_load_dwordx4 v47, s[44:47], s49 offen offset:3072 lds
    s_add_u32 s26, s21, 1
    s_and_b32 s26, s26, 3
    s_lshl_b32 s26, s26, 17
    s_add_u32 s26, s26, 65536
    s_add_u32 m0, s57, 98304
    s_add_u32 s49, s56, s26
    s_waitcnt vmcnt(40)
    buffer_load_dwordx4 v16, s[44:47], s49 offen offset:0 lds
    buffer_load_dwordx4 v17, s[44:47], s49 offen offset:1024 lds
    buffer_load_dwordx4 v18, s[44:47], s49 offen offset:2048 lds
    buffer_load_dwordx4 v19, s[44:47], s49 offen offset:3072 lds
    s_add_u32 m0, m0, 4096
    s_add_u32 s49, s49, 16384
    s_waitcnt vmcnt(40)
    buffer_load_dwordx4 v44, s[44:47], s49 offen offset:0 lds
    buffer_load_dwordx4 v45, s[44:47], s49 offen offset:1024 lds
    buffer_load_dwordx4 v46, s[44:47], s49 offen offset:2048 lds
    buffer_load_dwordx4 v47, s[44:47], s49 offen offset:3072 lds
    s_add_u32 m0, m0, 4096
    s_add_u32 s49, s49, 16384
    s_waitcnt vmcnt(40)
    buffer_load_dwordx4 v16, s[44:47], s49 offen offset:0 lds
    buffer_load_dwordx4 v17, s[44:47], s49 offen offset:1024 lds
    buffer_load_dwordx4 v18, s[44:47], s49 offen offset:2048 lds
    buffer_load_dwordx4 v19, s[44:47], s49 offen offset:3072 lds
    s_add_u32 m0, m0, 4096
    s_add_u32 s49, s49, 16384
    s_waitcnt vmcnt(40)
    buffer_load_dwordx4 v44, s[44:47], s49 offen offset:0 lds
    buffer_load_dwordx4 v45, s[44:47], s49 offen offset:1024 lds
    buffer_load_dwordx4 v46, s[44:47], s49 offen offset:2048 lds
    buffer_load_dwordx4 v47, s[44:47], s49 offen offset:3072 lds
    s_barrier
    s_add_u32 s26, s21, 2
    s_and_b32 s26, s26, 3
    s_lshl_b32 s26, s26, 17
    s_add_u32 m0, s57, 49152
    s_add_u32 s49, s56, s26
    s_waitcnt vmcnt(40)
    buffer_load_dwordx4 v16, s[44:47], s49 offen offset:0 lds
    buffer_load_dwordx4 v17, s[44:47], s49 offen offset:1024 lds
    buffer_load_dwordx4 v18, s[44:47], s49 offen offset:2048 lds
    buffer_load_dwordx4 v19, s[44:47], s49 offen offset:3072 lds
    s_add_u32 m0, m0, 4096
    s_add_u32 s49, s49, 16384
    s_waitcnt vmcnt(40)
    buffer_load_dwordx4 v44, s[44:47], s49 offen offset:0 lds
    buffer_load_dwordx4 v45, s[44:47], s49 offen offset:1024 lds
    buffer_load_dwordx4 v46, s[44:47], s49 offen offset:2048 lds
    buffer_load_dwordx4 v47, s[44:47], s49 offen offset:3072 lds
    s_add_u32 m0, m0, 4096
    s_add_u32 s49, s49, 16384
    s_waitcnt vmcnt(40)
    buffer_load_dwordx4 v16, s[44:47], s49 offen offset:0 lds
    buffer_load_dwordx4 v17, s[44:47], s49 offen offset:1024 lds
    buffer_load_dwordx4 v18, s[44:47], s49 offen offset:2048 lds
    buffer_load_dwordx4 v19, s[44:47], s49 offen offset:3072 lds
    s_add_u32 m0, m0, 4096
    s_add_u32 s49, s49, 16384
    s_waitcnt vmcnt(40)
    buffer_load_dwordx4 v44, s[44:47], s49 offen offset:0 lds
    buffer_load_dwordx4 v45, s[44:47], s49 offen offset:1024 lds
    buffer_load_dwordx4 v46, s[44:47], s49 offen offset:2048 lds
    buffer_load_dwordx4 v47, s[44:47], s49 offen offset:3072 lds
    s_add_u32 s26, s21, 2
    s_and_b32 s26, s26, 3
    s_lshl_b32 s26, s26, 17
    s_add_u32 s26, s26, 65536
    s_add_u32 m0, s57, 114688
    s_add_u32 s49, s56, s26
    s_waitcnt vmcnt(40)
    buffer_load_dwordx4 v16, s[44:47], s49 offen offset:0 lds
    buffer_load_dwordx4 v17, s[44:47], s49 offen offset:1024 lds
    buffer_load_dwordx4 v18, s[44:47], s49 offen offset:2048 lds
    buffer_load_dwordx4 v19, s[44:47], s49 offen offset:3072 lds
    s_add_u32 m0, m0, 4096
    s_add_u32 s49, s49, 16384
    s_waitcnt vmcnt(40)
    buffer_load_dwordx4 v44, s[44:47], s49 offen offset:0 lds
    buffer_load_dwordx4 v45, s[44:47], s49 offen offset:1024 lds
    buffer_load_dwordx4 v46, s[44:47], s49 offen offset:2048 lds
    buffer_load_dwordx4 v47, s[44:47], s49 offen offset:3072 lds
    s_add_u32 m0, m0, 4096
    s_add_u32 s49, s49, 16384
    s_waitcnt vmcnt(40)
    buffer_load_dwordx4 v16, s[44:47], s49 offen offset:0 lds
    buffer_load_dwordx4 v17, s[44:47], s49 offen offset:1024 lds
    buffer_load_dwordx4 v18, s[44:47], s49 offen offset:2048 lds
    buffer_load_dwordx4 v19, s[44:47], s49 offen offset:3072 lds
    s_add_u32 m0, m0, 4096
    s_add_u32 s49, s49, 16384
    s_waitcnt vmcnt(40)
    buffer_load_dwordx4 v44, s[44:47], s49 offen offset:0 lds
    buffer_load_dwordx4 v45, s[44:47], s49 offen offset:1024 lds
    buffer_load_dwordx4 v46, s[44:47], s49 offen offset:2048 lds
    buffer_load_dwordx4 v47, s[44:47], s49 offen offset:3072 lds
    s_add_u32 s26, s21, 3
    s_and_b32 s26, s26, 3
    s_lshl_b32 s26, s26, 17
    s_add_u32 m0, s57, 131072
    s_add_u32 s49, s56, s26
    s_waitcnt vmcnt(40)
    buffer_load_dwordx4 v16, s[44:47], s49 offen offset:0 lds
    buffer_load_dwordx4 v17, s[44:47], s49 offen offset:1024 lds
    buffer_load_dwordx4 v18, s[44:47], s49 offen offset:2048 lds
    buffer_load_dwordx4 v19, s[44:47], s49 offen offset:3072 lds
    s_add_u32 m0, m0, 4096
    s_add_u32 s49, s49, 16384
    s_waitcnt vmcnt(40)
    buffer_load_dwordx4 v44, s[44:47], s49 offen offset:0 lds
    buffer_load_dwordx4 v45, s[44:47], s49 offen offset:1024 lds
    buffer_load_dwordx4 v46, s[44:47], s49 offen offset:2048 lds
    buffer_load_dwordx4 v47, s[44:47], s49 offen offset:3072 lds
    s_add_u32 m0, m0, 4096
    s_add_u32 s49, s49, 16384
    s_waitcnt vmcnt(40)
    buffer_load_dwordx4 v16, s[44:47], s49 offen offset:0 lds
    buffer_load_dwordx4 v17, s[44:47], s49 offen offset:1024 lds
    buffer_load_dwordx4 v18, s[44:47], s49 offen offset:2048 lds
    buffer_load_dwordx4 v19, s[44:47], s49 offen offset:3072 lds
    s_add_u32 m0, m0, 4096
    s_add_u32 s49, s49, 16384
    s_waitcnt vmcnt(40)
    buffer_load_dwordx4 v44, s[44:47], s49 offen offset:0 lds
    buffer_load_dwordx4 v45, s[44:47], s49 offen offset:1024 lds
    buffer_load_dwordx4 v46, s[44:47], s49 offen offset:2048 lds
    buffer_load_dwordx4 v47, s[44:47], s49 offen offset:3072 lds
    s_add_u32 s26, s21, 3
    s_and_b32 s26, s26, 3
    s_lshl_b32 s26, s26, 17
    s_add_u32 s26, s26, 65536
    s_add_u32 m0, s57, 147456
    s_add_u32 s49, s56, s26
    s_waitcnt vmcnt(40)
    buffer_load_dwordx4 v16, s[44:47], s49 offen offset:0 lds
    buffer_load_dwordx4 v17, s[44:47], s49 offen offset:1024 lds
    buffer_load_dwordx4 v18, s[44:47], s49 offen offset:2048 lds
    buffer_load_dwordx4 v19, s[44:47], s49 offen offset:3072 lds
    s_add_u32 m0, m0, 4096
    s_add_u32 s49, s49, 16384
    s_waitcnt vmcnt(40)
    buffer_load_dwordx4 v44, s[44:47], s49 offen offset:0 lds
    buffer_load_dwordx4 v45, s[44:47], s49 offen offset:1024 lds
    buffer_load_dwordx4 v46, s[44:47], s49 offen offset:2048 lds
    buffer_load_dwordx4 v47, s[44:47], s49 offen offset:3072 lds
    s_add_u32 m0, m0, 4096
    s_add_u32 s49, s49, 16384
    s_waitcnt vmcnt(40)
    buffer_load_dwordx4 v16, s[44:47], s49 offen offset:0 lds
    buffer_load_dwordx4 v17, s[44:47], s49 offen offset:1024 lds
    buffer_load_dwordx4 v18, s[44:47], s49 offen offset:2048 lds
    buffer_load_dwordx4 v19, s[44:47], s49 offen offset:3072 lds
    s_add_u32 m0, m0, 4096
    s_add_u32 s49, s49, 16384
    s_waitcnt vmcnt(40)
    buffer_load_dwordx4 v44, s[44:47], s49 offen offset:0 lds
    buffer_load_dwordx4 v45, s[44:47], s49 offen offset:1024 lds
    buffer_load_dwordx4 v46, s[44:47], s49 offen offset:2048 lds
    buffer_load_dwordx4 v47, s[44:47], s49 offen offset:3072 lds
    s_barrier
    s_waitcnt vmcnt(32)
    s_waitcnt vmcnt(16)
    s_waitcnt vmcnt(0)
    s_barrier
    s_endpgm
L_aux:
    s_xor_b32 s26, s20, s22
    s_and_b32 s26, s26, 1
    s_or_b32 s54, s26, s21
    s_cmp_lg_u32 s54, 0
    s_cbranch_scc1 L_aux2
    v_mov_b32 v8, 0
    v_mov_b32 v9, 0
    v_mov_b32 v10, 0
    v_mov_b32 v11, 0
    v_mov_b32 v7, 1
    s_and_b32 s26, s24, 0xfffffff8
    v_mov_b32 v6, s26
    s_lshl_b32 s26, s26, 10
    s_add_u32 s26, s26, 16781312
    v_lshlrev_b32 v2, 4, v1
    v_add_u32 v2, s26, v2
    s_waitcnt lgkmcnt(0)
    global_store_dwordx4 v2, v[8:11], s[18:19] offset:-4096 sc1
    global_store_dwordx4 v2, v[8:11], s[18:19] offset:-3072 sc1
    global_store_dwordx4 v2, v[8:11], s[18:19] offset:-2048 sc1
    global_store_dwordx4 v2, v[8:11], s[18:19] offset:-1024 sc1
    global_store_dwordx4 v2, v[8:11], s[18:19] offset:0 sc1
    global_store_dwordx4 v2, v[8:11], s[18:19] offset:1024 sc1
    global_store_dwordx4 v2, v[8:11], s[18:19] offset:2048 sc1
    global_store_dwordx4 v2, v[8:11], s[18:19] offset:3072 sc1
    s_barrier
    s_waitcnt vmcnt(0)
    s_mov_b64 exec, 1
    global_store_dword v6, v7, s[16:17] sc1
    s_mov_b64 exec, -1
L_aux2:
    s_endpgm
L_comp:
    v_and_b32 v2, 31, v1
    v_lshrrev_b32 v3, 5, v1
    v_bfe_u32 v4, v1, 2, 2
    v_bfe_u32 v5, v1, 4, 1
    v_and_b32 v6, 3, v1
    v_and_b32 v7, 1, v1
    v_lshlrev_b32 v7, 1, v7
    v_bfe_u32 v224, v1, 1, 1
    v_or_b32 v7, v7, v224
    s_lshl_b32 s26, s25, 12
    v_bfe_u32 v224, v1, 1, 3
    v_xor_b32 v224, v224, v3
    v_lshlrev_b32 v224, 4, v224
    v_lshl_add_u32 v224, v2, 7, v224
    v_add_u32 v96, s26, v224
    v_xor_b32 v97, 32, v96
    v_xor_b32 v98, 64, v96
    v_xor_b32 v99, 96, v96
    v_lshrrev_b32 v224, 4, v1
    v_lshl_add_u32 v224, v224, 3, v4
    v_lshlrev_b32 v224, 8, v224
    v_lshl_add_u32 v224, v4, 6, v224
    v_lshl_add_u32 v224, v5, 5, v224
    v_lshl_add_u32 v224, v6, 3, v224
    v_add_u32 v224, 65536, v224
    v_xor_b32 v100, 0, v224
    v_xor_b32 v101, 32, v224
    v_xor_b32 v102, 64, v224
    v_xor_b32 v103, 96, v224
    v_xor_b32 v104, 128, v224
    v_xor_b32 v105, 160, v224
    v_xor_b32 v106, 192, v224
    v_xor_b32 v107, 224, v224
    v_bfe_u32 v224, v1, 1, 3
    v_lshrrev_b32 v225, 4, v1
    v_xor_b32 v224, v224, v225
    v_lshlrev_b32 v224, 4, v224
    v_and_b32 v225, 15, v1
    v_lshl_add_u32 v224, v225, 7, v224
    s_and_b32 s27, s20, 1
    s_lshl_b32 s27, s27, 11
    s_add_u32 s27, s27, s26
    v_add_u32 v97, s27, v224
    v_xor_b32 v96, 2048, v97
    v_xor_b32 v98, 64, v96
    v_xor_b32 v99, 64, v97
    v_mul_u32_u24 v224, 4, v3
    v_add_u32 v224, v224, v4
    v_lshlrev_b32 v224, 8, v224
    v_lshl_add_u32 v224, v5, 5, v224
    v_lshl_add_u32 v224, v6, 3, v224
    v_lshl_add_u32 v224, v4, 6, v224
    v_xor_b32 v8, 0, v224
    v_xor_b32 v9, 64, v224
    v_xor_b32 v10, 128, v224
    v_xor_b32 v11, 192, v224
    v_and_b32 v224, 15, v1
    v_xor_b32 v224, v224, v3
    v_lshlrev_b32 v224, 4, v224
    v_lshl_add_u32 v224, v2, 8, v224
    v_add_u32 v208, 131072, v224
    v_xor_b32 v209, 32, v208
    v_xor_b32 v210, 64, v208
    v_xor_b32 v211, 96, v208
    v_xor_b32 v212, 128, v208
    v_xor_b32 v213, 160, v208
    v_xor_b32 v214, 192, v208
    v_xor_b32 v215, 224, v208
    s_mov_b32 s48, 0x3e0293ee
    v_lshlrev_b32 v24, 4, v1
    v_mov_b32 v30, 1
    s_add_u32 s26, s21, 0
    s_and_b32 s26, s26, 3
    s_and_b32 s27, s24, 0xfffffffc
    s_add_u32 s26, s26, s27
    s_lshl2_add_u32 s26, s26, s25
    s_lshl_b32 s60, s26, 13
    s_add_u32 s26, s21, 1
    s_and_b32 s26, s26, 3
    s_and_b32 s27, s24, 0xfffffffc
    s_add_u32 s26, s26, s27
    s_lshl2_add_u32 s26, s26, s25
    s_lshl_b32 s61, s26, 13
    s_add_u32 s26, s21, 2
    s_and_b32 s26, s26, 3
    s_and_b32 s27, s24, 0xfffffffc
    s_add_u32 s26, s26, s27
    s_lshl2_add_u32 s26, s26, s25
    s_lshl_b32 s62, s26, 13
    s_add_u32 s26, s21, 3
    s_and_b32 s26, s26, 3
    s_and_b32 s27, s24, 0xfffffffc
    s_add_u32 s26, s26, s27
    s_lshl2_add_u32 s26, s26, s25
    s_lshl_b32 s63, s26, 13
    s_lshl2_add_u32 s26, s24, s25
    s_lshl_b32 s26, s26, 8
    s_add_u32 s64, s26, 16777216
    s_lshr_b32 s26, s20, 1
    s_and_b32 s27, s20, 1
    s_xor_b32 s27, s27, 1
    s_lshl_b32 s49, s22, 5
    s_add_u32 s49, s49, s21
    s_lshl2_add_u32 s49, s49, s25
    s_lshl_b32 s49, s49, 3
    s_add_u32 s2, s26, 1
    s_and_b32 s2, s2, 3
    s_lshl_b32 s86, s2, 6
    s_or_b32 s87, s86, 32
    s_xor_b32 s3, s27, 0
    s_lshl1_add_u32 s3, s2, s3
    s_lshl_b32 s52, s3, 7
    s_add_u32 s52, s52, s49
    s_lshl_b32 s52, s52, 10
    s_add_u32 s52, s52, 8395776
    s_xor_b32 s3, s27, 1
    s_lshl1_add_u32 s3, s2, s3
    s_lshl_b32 s53, s3, 7
    s_add_u32 s53, s53, s49
    s_lshl_b32 s53, s53, 10
    s_add_u32 s53, s53, 8394752
    s_add_u32 s2, s26, 2
    s_and_b32 s2, s2, 3
    s_lshl_b32 s88, s2, 6
    s_or_b32 s89, s88, 32
    s_xor_b32 s3, s27, 0
    s_lshl1_add_u32 s3, s2, s3
    s_lshl_b32 s54, s3, 7
    s_add_u32 s54, s54, s49
    s_lshl_b32 s54, s54, 10
    s_add_u32 s54, s54, 8393728
    s_xor_b32 s3, s27, 1
    s_lshl1_add_u32 s3, s2, s3
    s_lshl_b32 s55, s3, 7
    s_add_u32 s55, s55, s49
    s_lshl_b32 s55, s55, 10
    s_add_u32 s55, s55, 8392704
    s_add_u32 s2, s26, 3
    s_and_b32 s2, s2, 3
    s_lshl_b32 s90, s2, 6
    s_or_b32 s91, s90, 32
    s_xor_b32 s3, s27, 0
    s_lshl1_add_u32 s3, s2, s3
    s_lshl_b32 s56, s3, 7
    s_add_u32 s56, s56, s49
    s_lshl_b32 s56, s56, 10
    s_add_u32 s56, s56, 8391680
    s_xor_b32 s3, s27, 1
    s_lshl1_add_u32 s3, s2, s3
    s_lshl_b32 s57, s3, 7
    s_add_u32 s57, s57, s49
    s_lshl_b32 s57, s57, 10
    s_add_u32 s57, s57, 8390656
    s_add_u32 s2, s26, 4
    s_and_b32 s2, s2, 3
    s_lshl_b32 s92, s2, 6
    s_or_b32 s93, s92, 32
    s_xor_b32 s3, s27, 0
    s_lshl1_add_u32 s3, s2, s3
    s_lshl_b32 s58, s3, 7
    s_add_u32 s58, s58, s49
    s_lshl_b32 s58, s58, 10
    s_add_u32 s58, s58, 8389632
    s_xor_b32 s3, s27, 1
    s_lshl1_add_u32 s3, s2, s3
    s_lshl_b32 s59, s3, 7
    s_add_u32 s59, s59, s49
    s_lshl_b32 s59, s59, 10
    s_add_u32 s59, s59, 8388608
    v_lshl_add_u32 v224, v3, 2, v4
    v_lshl_add_u32 v224, v5, 4, v224
    v_lshlrev_b32 v224, 8, v224
    v_lshl_add_u32 v224, v4, 6, v224
    v_lshl_add_u32 v224, v5, 5, v224
    v_lshl_add_u32 v224, v6, 3, v224
    v_add_u32 v224, 32768, v224
    v_xor_b32 v12, s86, v224
    v_xor_b32 v13, s87, v224
    v_xor_b32 v14, s88, v224
    v_xor_b32 v15, s89, v224
    v_xor_b32 v16, s90, v224
    v_xor_b32 v17, s91, v224
    v_xor_b32 v18, s92, v224
    v_xor_b32 v19, s93, v224
    v_and_b32 v224, 3, v1
    v_max_u32 v27, 1, v224
    v_lshlrev_b32 v27, 2, v27
    s_and_b32 s26, s24, 0xfffffffc
    s_lshl2_add_u32 s26, s26, s25
    s_lshl_b32 s26, s26, 8
    s_add_u32 s26, s26, 16777344
    v_lshlrev_b32 v25, 10, v224
    v_sub_u32 v224, s21, v224
    v_and_b32 v224, 3, v224
    v_lshl_add_u32 v25, v224, 2, v25
    v_add_u32 v25, s26, v25
    v_and_b32 v224, 7, v1
    v_max_u32 v28, 1, v224
    v_lshlrev_b32 v28, 2, v28
    s_lshl_b32 s26, s49, 5
    s_add_u32 s26, s26, 16777216
    s_or_b32 s27, s20, 1
    s_add_u32 s27, s27, 1
    v_add_u32 v225, s27, v224
    v_and_b32 v225, 7, v225
    s_and_b32 s27, s20, 1
    s_xor_b32 s27, s27, 1
    v_xor_b32 v225, s27, v225
    v_lshlrev_b32 v26, 12, v225
    v_sub_u32 v224, 7, v224
    v_lshl_add_u32 v26, v224, 2, v26
    v_add_u32 v26, s26, v26
    s_lshl_b32 s26, s22, 17
    s_lshl_b32 s27, s25, 15
    s_add_u32 s26, s26, s27
    s_lshl_b32 s27, s21, 8
    s_add_u32 s26, s26, s27
    s_lshr_b32 s27, s20, 1
    s_lshl_b32 s27, s27, 6
    s_add_u32 s26, s26, s27
    s_and_b32 s27, s20, 1
    s_lshl_b32 s27, s27, 14
    s_add_u32 s26, s26, s27
    v_and_b32 v29, 15, v1
    v_lshlrev_b32 v29, 10, v29
    v_lshl_add_u32 v29, v3, 4, v29
    v_lshl_add_u32 v29, v5, 5, v29
    v_add_u32 v29, s26, v29
    v_and_b32 v31, 3, v1
    s_lshl_b32 s26, s22, 5
    v_lshl_add_u32 v31, v31, 3, s26
    s_mov_b32 s69, 0
    s_waitcnt lgkmcnt(0)
    s_mov_b32 s28, s18
    s_and_b32 s29, s19, 0xffff
    s_mov_b32 s30, 268435456
    s_mov_b32 s31, 0x20000
    s_mov_b32 s32, s14
    s_and_b32 s33, s15, 0xffff
    s_mov_b32 s34, 1048576
    s_mov_b32 s35, 0x20000
    s_barrier
    ds_read_b128 v[192:195], v96 offset:0
    ds_read_b128 v[196:199], v97 offset:0
    ds_read_b64_tr_b16 v[224:225], v100 offset:0
    ds_read_b64_tr_b16 v[226:227], v100 offset:1024
    ds_read_b64_tr_b16 v[228:229], v101 offset:0
    ds_read_b64_tr_b16 v[230:231], v101 offset:1024
    ds_read_b64_tr_b16 v[232:233], v102 offset:0
    ds_read_b64_tr_b16 v[234:235], v102 offset:1024
    ds_read_b64_tr_b16 v[236:237], v103 offset:0
    ds_read_b64_tr_b16 v[238:239], v103 offset:1024
    ds_read_b64_tr_b16 v[240:241], v104 offset:0
    ds_read_b64_tr_b16 v[242:243], v104 offset:1024
    ds_read_b64_tr_b16 v[244:245], v105 offset:0
    ds_read_b64_tr_b16 v[246:247], v105 offset:1024
    ds_read_b64_tr_b16 v[248:249], v106 offset:0
    ds_read_b64_tr_b16 v[250:251], v106 offset:1024
    ds_read_b64_tr_b16 v[252:253], v107 offset:0
    ds_read_b64_tr_b16 v[254:255], v107 offset:1024
    s_waitcnt lgkmcnt(10)
    v_mfma_f32_16x16x32_bf16 v[32:35], v[224:227], v[192:195], 0
    ds_read_b128 v[200:203], v98 offset:0
    v_mfma_f32_16x16x32_bf16 v[36:39], v[224:227], v[196:199], 0
    ds_read_b64_tr_b16 v[224:225], v100 offset:8192
    v_mfma_f32_16x16x32_bf16 v[40:43], v[228:231], v[192:195], 0
    ds_read_b64_tr_b16 v[226:227], v100 offset:9216
    ds_read_b128 v[204:207], v99 offset:0
    v_mfma_f32_16x16x32_bf16 v[44:47], v[228:231], v[196:199], 0
    ds_read_b64_tr_b16 v[228:229], v101 offset:8192
    v_mfma_f32_16x16x32_bf16 v[48:51], v[232:235], v[192:195], 0
    ds_read_b64_tr_b16 v[230:231], v101 offset:9216
    v_mfma_f32_16x16x32_bf16 v[52:55], v[232:235], v[196:199], 0
    ds_read_b64_tr_b16 v[232:233], v102 offset:8192
    s_waitcnt lgkmcnt(11)
    v_mfma_f32_16x16x32_bf16 v[56:59], v[236:239], v[192:195], 0
    ds_read_b64_tr_b16 v[234:235], v102 offset:9216
    v_mfma_f32_16x16x32_bf16 v[60:63], v[236:239], v[196:199], 0
    ds_read_b64_tr_b16 v[236:237], v103 offset:8192
    v_mfma_f32_16x16x32_bf16 v[64:67], v[240:243], v[192:195], 0
    ds_read_b64_tr_b16 v[238:239], v103 offset:9216
    v_mfma_f32_16x16x32_bf16 v[68:71], v[240:243], v[196:199], 0
    ds_read_b64_tr_b16 v[240:241], v104 offset:8192
    v_mfma_f32_16x16x32_bf16 v[72:75], v[244:247], v[192:195], 0
    ds_read_b64_tr_b16 v[242:243], v104 offset:9216
    v_mfma_f32_16x16x32_bf16 v[76:79], v[244:247], v[196:199], 0
    ds_read_b64_tr_b16 v[244:245], v105 offset:8192
    s_waitcnt lgkmcnt(11)
    v_mfma_f32_16x16x32_bf16 v[80:83], v[248:251], v[192:195], 0
    ds_read_b64_tr_b16 v[246:247], v105 offset:9216
    v_mfma_f32_16x16x32_bf16 v[84:87], v[248:251], v[196:199], 0
    ds_read_b64_tr_b16 v[248:249], v106 offset:8192
    v_mfma_f32_16x16x32_bf16 v[88:91], v[252:255], v[192:195], 0
    ds_read_b64_tr_b16 v[250:251], v106 offset:9216
    v_mfma_f32_16x16x32_bf16 v[92:95], v[252:255], v[196:199], 0
    ds_read_b64_tr_b16 v[252:253], v107 offset:8192
    ds_read_b64_tr_b16 v[254:255], v107 offset:9216
    s_waitcnt lgkmcnt(0)
    s_barrier
    v_mfma_f32_16x16x32_bf16 v[32:35], v[224:227], v[200:203], v[32:35]
    ds_read_b128 v[192:195], v96 offset:16384
    v_mfma_f32_16x16x32_bf16 v[36:39], v[224:227], v[204:207], v[36:39]
    ds_read_b64_tr_b16 v[224:225], v100 offset:16384
    v_mfma_f32_16x16x32_bf16 v[40:43], v[228:231], v[200:203], v[40:43]
    ds_read_b64_tr_b16 v[226:227], v100 offset:17408
    ds_read_b128 v[196:199], v97 offset:16384
    v_mfma_f32_16x16x32_bf16 v[44:47], v[228:231], v[204:207], v[44:47]
    ds_read_b64_tr_b16 v[228:229], v101 offset:16384
    v_mfma_f32_16x16x32_bf16 v[48:51], v[232:235], v[200:203], v[48:51]
    ds_read_b64_tr_b16 v[230:231], v101 offset:17408
    v_mfma_f32_16x16x32_bf16 v[52:55], v[232:235], v[204:207], v[52:55]
    ds_read_b64_tr_b16 v[232:233], v102 offset:16384
    v_mfma_f32_16x16x32_bf16 v[56:59], v[236:239], v[200:203], v[56:59]
    ds_read_b64_tr_b16 v[234:235], v102 offset:17408
    v_mfma_f32_16x16x32_bf16 v[60:63], v[236:239], v[204:207], v[60:63]
    ds_read_b64_tr_b16 v[236:237], v103 offset:16384
    v_mfma_f32_16x16x32_bf16 v[64:67], v[240:243], v[200:203], v[64:67]
    ds_read_b64_tr_b16 v[238:239], v103 offset:17408
    v_mfma_f32_16x16x32_bf16 v[68:71], v[240:243], v[204:207], v[68:71]
    ds_read_b64_tr_b16 v[240:241], v104 offset:16384
    v_mfma_f32_16x16x32_bf16 v[72:75], v[244:247], v[200:203], v[72:75]
    ds_read_b64_tr_b16 v[242:243], v104 offset:17408
    v_mfma_f32_16x16x32_bf16 v[76:79], v[244:247], v[204:207], v[76:79]
    ds_read_b64_tr_b16 v[244:245], v105 offset:16384
    v_mfma_f32_16x16x32_bf16 v[80:83], v[248:251], v[200:203], v[80:83]
    ds_read_b64_tr_b16 v[246:247], v105 offset:17408
    v_mfma_f32_16x16x32_bf16 v[84:87], v[248:251], v[204:207], v[84:87]
    ds_read_b64_tr_b16 v[248:249], v106 offset:16384
    v_mfma_f32_16x16x32_bf16 v[88:91], v[252:255], v[200:203], v[88:91]
    ds_read_b64_tr_b16 v[250:251], v106 offset:17408
    v_mfma_f32_16x16x32_bf16 v[92:95], v[252:255], v[204:207], v[92:95]
    ds_read_b64_tr_b16 v[252:253], v107 offset:16384
    s_waitcnt lgkmcnt(10)
    v_mfma_f32_16x16x32_bf16 v[32:35], v[224:227], v[192:195], v[32:35]
    ds_read_b64_tr_b16 v[254:255], v107 offset:17408
    ds_read_b128 v[200:203], v98 offset:16384
    v_mfma_f32_16x16x32_bf16 v[36:39], v[224:227], v[196:199], v[36:39]
    ds_read_b64_tr_b16 v[224:225], v100 offset:24576
    v_mfma_f32_16x16x32_bf16 v[40:43], v[228:231], v[192:195], v[40:43]
    ds_read_b64_tr_b16 v[226:227], v100 offset:25600
    ds_read_b128 v[204:207], v99 offset:16384
    v_mfma_f32_16x16x32_bf16 v[44:47], v[228:231], v[196:199], v[44:47]
    ds_read_b64_tr_b16 v[228:229], v101 offset:24576
    s_waitcnt lgkmcnt(11)
    v_mfma_f32_16x16x32_bf16 v[48:51], v[232:235], v[192:195], v[48:51]
    ds_read_b64_tr_b16 v[230:231], v101 offset:25600
    v_mfma_f32_16x16x32_bf16 v[52:55], v[232:235], v[196:199], v[52:55]
    ds_read_b64_tr_b16 v[232:233], v102 offset:24576
    v_mfma_f32_16x16x32_bf16 v[56:59], v[236:239], v[192:195], v[56:59]
    ds_read_b64_tr_b16 v[234:235], v102 offset:25600
    v_mfma_f32_16x16x32_bf16 v[60:63], v[236:239], v[196:199], v[60:63]
    ds_read_b64_tr_b16 v[236:237], v103 offset:24576
    v_mfma_f32_16x16x32_bf16 v[64:67], v[240:243], v[192:195], v[64:67]
    ds_read_b64_tr_b16 v[238:239], v103 offset:25600
    v_mfma_f32_16x16x32_bf16 v[68:71], v[240:243], v[196:199], v[68:71]
    ds_read_b64_tr_b16 v[240:241], v104 offset:24576
    s_waitcnt lgkmcnt(11)
    v_mfma_f32_16x16x32_bf16 v[72:75], v[244:247], v[192:195], v[72:75]
    ds_read_b64_tr_b16 v[242:243], v104 offset:25600
    v_mfma_f32_16x16x32_bf16 v[76:79], v[244:247], v[196:199], v[76:79]
    ds_read_b64_tr_b16 v[244:245], v105 offset:24576
    v_mfma_f32_16x16x32_bf16 v[80:83], v[248:251], v[192:195], v[80:83]
    ds_read_b64_tr_b16 v[246:247], v105 offset:25600
    v_mfma_f32_16x16x32_bf16 v[84:87], v[248:251], v[196:199], v[84:87]
    ds_read_b64_tr_b16 v[248:249], v106 offset:24576
    v_mfma_f32_16x16x32_bf16 v[88:91], v[252:255], v[192:195], v[88:91]
    ds_read_b64_tr_b16 v[250:251], v106 offset:25600
    v_mfma_f32_16x16x32_bf16 v[92:95], v[252:255], v[196:199], v[92:95]
    ds_read_b64_tr_b16 v[252:253], v107 offset:24576
    ds_read_b64_tr_b16 v[254:255], v107 offset:25600
    s_waitcnt lgkmcnt(0)
    s_barrier
    v_mfma_f32_16x16x32_bf16 v[32:35], v[224:227], v[200:203], v[32:35]
    ds_read_b128 v[192:195], v96 offset:32768
    v_mfma_f32_16x16x32_bf16 v[36:39], v[224:227], v[204:207], v[36:39]
    ds_read_b64_tr_b16 v[224:225], v100 offset:32768
    v_mfma_f32_16x16x32_bf16 v[40:43], v[228:231], v[200:203], v[40:43]
    ds_read_b64_tr_b16 v[226:227], v100 offset:33792
    ds_read_b128 v[196:199], v97 offset:32768
    v_mfma_f32_16x16x32_bf16 v[44:47], v[228:231], v[204:207], v[44:47]
    ds_read_b64_tr_b16 v[228:229], v101 offset:32768
    v_mfma_f32_16x16x32_bf16 v[48:51], v[232:235], v[200:203], v[48:51]
    ds_read_b64_tr_b16 v[230:231], v101 offset:33792
    v_mfma_f32_16x16x32_bf16 v[52:55], v[232:235], v[204:207], v[52:55]
    ds_read_b64_tr_b16 v[232:233], v102 offset:32768
    v_mfma_f32_16x16x32_bf16 v[56:59], v[236:239], v[200:203], v[56:59]
    ds_read_b64_tr_b16 v[234:235], v102 offset:33792
    v_mfma_f32_16x16x32_bf16 v[60:63], v[236:239], v[204:207], v[60:63]
    ds_read_b64_tr_b16 v[236:237], v103 offset:32768
    v_mfma_f32_16x16x32_bf16 v[64:67], v[240:243], v[200:203], v[64:67]
    ds_read_b64_tr_b16 v[238:239], v103 offset:33792
    v_mfma_f32_16x16x32_bf16 v[68:71], v[240:243], v[204:207], v[68:71]
    ds_read_b64_tr_b16 v[240:241], v104 offset:32768
    v_mfma_f32_16x16x32_bf16 v[72:75], v[244:247], v[200:203], v[72:75]
    ds_read_b64_tr_b16 v[242:243], v104 offset:33792
    v_mfma_f32_16x16x32_bf16 v[76:79], v[244:247], v[204:207], v[76:79]
    ds_read_b64_tr_b16 v[244:245], v105 offset:32768
    v_mfma_f32_16x16x32_bf16 v[80:83], v[248:251], v[200:203], v[80:83]
    ds_read_b64_tr_b16 v[246:247], v105 offset:33792
    v_mfma_f32_16x16x32_bf16 v[84:87], v[248:251], v[204:207], v[84:87]
    ds_read_b64_tr_b16 v[248:249], v106 offset:32768
    v_mfma_f32_16x16x32_bf16 v[88:91], v[252:255], v[200:203], v[88:91]
    ds_read_b64_tr_b16 v[250:251], v106 offset:33792
    v_mfma_f32_16x16x32_bf16 v[92:95], v[252:255], v[204:207], v[92:95]
    ds_read_b64_tr_b16 v[252:253], v107 offset:32768
    s_waitcnt lgkmcnt(10)
    v_mfma_f32_16x16x32_bf16 v[32:35], v[224:227], v[192:195], v[32:35]
    ds_read_b64_tr_b16 v[254:255], v107 offset:33792
    ds_read_b128 v[200:203], v98 offset:32768
    v_mfma_f32_16x16x32_bf16 v[36:39], v[224:227], v[196:199], v[36:39]
    ds_read_b64_tr_b16 v[224:225], v100 offset:40960
    v_mfma_f32_16x16x32_bf16 v[40:43], v[228:231], v[192:195], v[40:43]
    ds_read_b64_tr_b16 v[226:227], v100 offset:41984
    ds_read_b128 v[204:207], v99 offset:32768
    v_mfma_f32_16x16x32_bf16 v[44:47], v[228:231], v[196:199], v[44:47]
    ds_read_b64_tr_b16 v[228:229], v101 offset:40960
    s_waitcnt lgkmcnt(11)
    v_mfma_f32_16x16x32_bf16 v[48:51], v[232:235], v[192:195], v[48:51]
    ds_read_b64_tr_b16 v[230:231], v101 offset:41984
    v_mfma_f32_16x16x32_bf16 v[52:55], v[232:235], v[196:199], v[52:55]
    ds_read_b64_tr_b16 v[232:233], v102 offset:40960
    v_mfma_f32_16x16x32_bf16 v[56:59], v[236:239], v[192:195], v[56:59]
    ds_read_b64_tr_b16 v[234:235], v102 offset:41984
    v_mfma_f32_16x16x32_bf16 v[60:63], v[236:239], v[196:199], v[60:63]
    ds_read_b64_tr_b16 v[236:237], v103 offset:40960
    v_mfma_f32_16x16x32_bf16 v[64:67], v[240:243], v[192:195], v[64:67]
    ds_read_b64_tr_b16 v[238:239], v103 offset:41984
    v_mfma_f32_16x16x32_bf16 v[68:71], v[240:243], v[196:199], v[68:71]
    ds_read_b64_tr_b16 v[240:241], v104 offset:40960
    s_waitcnt lgkmcnt(11)
    v_mfma_f32_16x16x32_bf16 v[72:75], v[244:247], v[192:195], v[72:75]
    ds_read_b64_tr_b16 v[242:243], v104 offset:41984
    v_mfma_f32_16x16x32_bf16 v[76:79], v[244:247], v[196:199], v[76:79]
    ds_read_b64_tr_b16 v[244:245], v105 offset:40960
    v_mfma_f32_16x16x32_bf16 v[80:83], v[248:251], v[192:195], v[80:83]
    ds_read_b64_tr_b16 v[246:247], v105 offset:41984
    v_mfma_f32_16x16x32_bf16 v[84:87], v[248:251], v[196:199], v[84:87]
    ds_read_b64_tr_b16 v[248:249], v106 offset:40960
    v_mfma_f32_16x16x32_bf16 v[88:91], v[252:255], v[192:195], v[88:91]
    ds_read_b64_tr_b16 v[250:251], v106 offset:41984
    v_mfma_f32_16x16x32_bf16 v[92:95], v[252:255], v[196:199], v[92:95]
    ds_read_b64_tr_b16 v[252:253], v107 offset:40960
    ds_read_b64_tr_b16 v[254:255], v107 offset:41984
    s_waitcnt lgkmcnt(0)
    s_barrier
    v_mfma_f32_16x16x32_bf16 v[32:35], v[224:227], v[200:203], v[32:35]
    ds_read_b128 v[192:195], v96 offset:49152
    v_mfma_f32_16x16x32_bf16 v[36:39], v[224:227], v[204:207], v[36:39]
    ds_read_b64_tr_b16 v[224:225], v100 offset:49152
    v_mfma_f32_16x16x32_bf16 v[40:43], v[228:231], v[200:203], v[40:43]
    ds_read_b64_tr_b16 v[226:227], v100 offset:50176
    ds_read_b128 v[196:199], v97 offset:49152
    v_mfma_f32_16x16x32_bf16 v[44:47], v[228:231], v[204:207], v[44:47]
    ds_read_b64_tr_b16 v[228:229], v101 offset:49152
    v_mfma_f32_16x16x32_bf16 v[48:51], v[232:235], v[200:203], v[48:51]
    ds_read_b64_tr_b16 v[230:231], v101 offset:50176
    v_mfma_f32_16x16x32_bf16 v[52:55], v[232:235], v[204:207], v[52:55]
    ds_read_b64_tr_b16 v[232:233], v102 offset:49152
    v_mfma_f32_16x16x32_bf16 v[56:59], v[236:239], v[200:203], v[56:59]
    ds_read_b64_tr_b16 v[234:235], v102 offset:50176
    v_mfma_f32_16x16x32_bf16 v[60:63], v[236:239], v[204:207], v[60:63]
    ds_read_b64_tr_b16 v[236:237], v103 offset:49152
    v_mfma_f32_16x16x32_bf16 v[64:67], v[240:243], v[200:203], v[64:67]
    ds_read_b64_tr_b16 v[238:239], v103 offset:50176
    v_mfma_f32_16x16x32_bf16 v[68:71], v[240:243], v[204:207], v[68:71]
    ds_read_b64_tr_b16 v[240:241], v104 offset:49152
    v_mfma_f32_16x16x32_bf16 v[72:75], v[244:247], v[200:203], v[72:75]
    ds_read_b64_tr_b16 v[242:243], v104 offset:50176
    v_mfma_f32_16x16x32_bf16 v[76:79], v[244:247], v[204:207], v[76:79]
    ds_read_b64_tr_b16 v[244:245], v105 offset:49152
    v_mfma_f32_16x16x32_bf16 v[80:83], v[248:251], v[200:203], v[80:83]
    ds_read_b64_tr_b16 v[246:247], v105 offset:50176
    v_mfma_f32_16x16x32_bf16 v[84:87], v[248:251], v[204:207], v[84:87]
    ds_read_b64_tr_b16 v[248:249], v106 offset:49152
    v_mfma_f32_16x16x32_bf16 v[88:91], v[252:255], v[200:203], v[88:91]
    ds_read_b64_tr_b16 v[250:251], v106 offset:50176
    v_mfma_f32_16x16x32_bf16 v[92:95], v[252:255], v[204:207], v[92:95]
    ds_read_b64_tr_b16 v[252:253], v107 offset:49152
    s_waitcnt lgkmcnt(10)
    v_mfma_f32_16x16x32_bf16 v[32:35], v[224:227], v[192:195], v[32:35]
    ds_read_b64_tr_b16 v[254:255], v107 offset:50176
    ds_read_b128 v[200:203], v98 offset:49152
    v_mfma_f32_16x16x32_bf16 v[36:39], v[224:227], v[196:199], v[36:39]
    ds_read_b64_tr_b16 v[224:225], v100 offset:57344
    v_mfma_f32_16x16x32_bf16 v[40:43], v[228:231], v[192:195], v[40:43]
    ds_read_b64_tr_b16 v[226:227], v100 offset:58368
    ds_read_b128 v[204:207], v99 offset:49152
    v_mfma_f32_16x16x32_bf16 v[44:47], v[228:231], v[196:199], v[44:47]
    ds_read_b64_tr_b16 v[228:229], v101 offset:57344
    s_waitcnt lgkmcnt(11)
    v_mfma_f32_16x16x32_bf16 v[48:51], v[232:235], v[192:195], v[48:51]
    ds_read_b64_tr_b16 v[230:231], v101 offset:58368
    v_mfma_f32_16x16x32_bf16 v[52:55], v[232:235], v[196:199], v[52:55]
    ds_read_b64_tr_b16 v[232:233], v102 offset:57344
    v_mfma_f32_16x16x32_bf16 v[56:59], v[236:239], v[192:195], v[56:59]
    ds_read_b64_tr_b16 v[234:235], v102 offset:58368
    v_mfma_f32_16x16x32_bf16 v[60:63], v[236:239], v[196:199], v[60:63]
    ds_read_b64_tr_b16 v[236:237], v103 offset:57344
    v_mfma_f32_16x16x32_bf16 v[64:67], v[240:243], v[192:195], v[64:67]
    ds_read_b64_tr_b16 v[238:239], v103 offset:58368
    v_mfma_f32_16x16x32_bf16 v[68:71], v[240:243], v[196:199], v[68:71]
    ds_read_b64_tr_b16 v[240:241], v104 offset:57344
    s_waitcnt lgkmcnt(11)
    v_mfma_f32_16x16x32_bf16 v[72:75], v[244:247], v[192:195], v[72:75]
    ds_read_b64_tr_b16 v[242:243], v104 offset:58368
    v_mfma_f32_16x16x32_bf16 v[76:79], v[244:247], v[196:199], v[76:79]
    ds_read_b64_tr_b16 v[244:245], v105 offset:57344
    v_mfma_f32_16x16x32_bf16 v[80:83], v[248:251], v[192:195], v[80:83]
    ds_read_b64_tr_b16 v[246:247], v105 offset:58368
    v_mfma_f32_16x16x32_bf16 v[84:87], v[248:251], v[196:199], v[84:87]
    ds_read_b64_tr_b16 v[248:249], v106 offset:57344
    v_mfma_f32_16x16x32_bf16 v[88:91], v[252:255], v[192:195], v[88:91]
    ds_read_b64_tr_b16 v[250:251], v106 offset:58368
    v_mfma_f32_16x16x32_bf16 v[92:95], v[252:255], v[196:199], v[92:95]
    ds_read_b64_tr_b16 v[252:253], v107 offset:57344
    ds_read_b64_tr_b16 v[254:255], v107 offset:58368
    s_waitcnt lgkmcnt(0)
    s_barrier
    v_mfma_f32_16x16x32_bf16 v[32:35], v[224:227], v[200:203], v[32:35]
    ds_read_b128 v[192:195], v96 offset:0
    v_mfma_f32_16x16x32_bf16 v[36:39], v[224:227], v[204:207], v[36:39]
    ds_read_b64_tr_b16 v[224:225], v100 offset:0
    v_mfma_f32_16x16x32_bf16 v[40:43], v[228:231], v[200:203], v[40:43]
    ds_read_b64_tr_b16 v[226:227], v100 offset:1024
    ds_read_b128 v[196:199], v97 offset:0
    v_mfma_f32_16x16x32_bf16 v[44:47], v[228:231], v[204:207], v[44:47]
    ds_read_b64_tr_b16 v[228:229], v101 offset:0
    v_mfma_f32_16x16x32_bf16 v[48:51], v[232:235], v[200:203], v[48:51]
    ds_read_b64_tr_b16 v[230:231], v101 offset:1024
    v_mfma_f32_16x16x32_bf16 v[52:55], v[232:235], v[204:207], v[52:55]
    ds_read_b64_tr_b16 v[232:233], v102 offset:0
    v_mfma_f32_16x16x32_bf16 v[56:59], v[236:239], v[200:203], v[56:59]
    ds_read_b64_tr_b16 v[234:235], v102 offset:1024
    v_mfma_f32_16x16x32_bf16 v[60:63], v[236:239], v[204:207], v[60:63]
    ds_read_b64_tr_b16 v[236:237], v103 offset:0
    v_mfma_f32_16x16x32_bf16 v[64:67], v[240:243], v[200:203], v[64:67]
    ds_read_b64_tr_b16 v[238:239], v103 offset:1024
    v_mfma_f32_16x16x32_bf16 v[68:71], v[240:243], v[204:207], v[68:71]
    ds_read_b64_tr_b16 v[240:241], v104 offset:0
    v_mfma_f32_16x16x32_bf16 v[72:75], v[244:247], v[200:203], v[72:75]
    ds_read_b64_tr_b16 v[242:243], v104 offset:1024
    v_mfma_f32_16x16x32_bf16 v[76:79], v[244:247], v[204:207], v[76:79]
    ds_read_b64_tr_b16 v[244:245], v105 offset:0
    v_mfma_f32_16x16x32_bf16 v[80:83], v[248:251], v[200:203], v[80:83]
    ds_read_b64_tr_b16 v[246:247], v105 offset:1024
    v_mfma_f32_16x16x32_bf16 v[84:87], v[248:251], v[204:207], v[84:87]
    ds_read_b64_tr_b16 v[248:249], v106 offset:0
    v_mfma_f32_16x16x32_bf16 v[88:91], v[252:255], v[200:203], v[88:91]
    ds_read_b64_tr_b16 v[250:251], v106 offset:1024
    v_mfma_f32_16x16x32_bf16 v[92:95], v[252:255], v[204:207], v[92:95]
    ds_read_b64_tr_b16 v[252:253], v107 offset:0
    s_waitcnt lgkmcnt(10)
    v_mfma_f32_16x16x32_bf16 v[32:35], v[224:227], v[192:195], v[32:35]
    ds_read_b64_tr_b16 v[254:255], v107 offset:1024
    ds_read_b128 v[200:203], v98 offset:0
    v_mfma_f32_16x16x32_bf16 v[36:39], v[224:227], v[196:199], v[36:39]
    ds_read_b64_tr_b16 v[224:225], v100 offset:8192
    v_mfma_f32_16x16x32_bf16 v[40:43], v[228:231], v[192:195], v[40:43]
    ds_read_b64_tr_b16 v[226:227], v100 offset:9216
    ds_read_b128 v[204:207], v99 offset:0
    v_mfma_f32_16x16x32_bf16 v[44:47], v[228:231], v[196:199], v[44:47]
    ds_read_b64_tr_b16 v[228:229], v101 offset:8192
    s_waitcnt lgkmcnt(11)
    v_mfma_f32_16x16x32_bf16 v[48:51], v[232:235], v[192:195], v[48:51]
    ds_read_b64_tr_b16 v[230:231], v101 offset:9216
    v_mfma_f32_16x16x32_bf16 v[52:55], v[232:235], v[196:199], v[52:55]
    ds_read_b64_tr_b16 v[232:233], v102 offset:8192
    v_mfma_f32_16x16x32_bf16 v[56:59], v[236:239], v[192:195], v[56:59]
    ds_read_b64_tr_b16 v[234:235], v102 offset:9216
    v_mfma_f32_16x16x32_bf16 v[60:63], v[236:239], v[196:199], v[60:63]
    ds_read_b64_tr_b16 v[236:237], v103 offset:8192
    v_mfma_f32_16x16x32_bf16 v[64:67], v[240:243], v[192:195], v[64:67]
    ds_read_b64_tr_b16 v[238:239], v103 offset:9216
    v_mfma_f32_16x16x32_bf16 v[68:71], v[240:243], v[196:199], v[68:71]
    ds_read_b64_tr_b16 v[240:241], v104 offset:8192
    s_waitcnt lgkmcnt(11)
    v_mfma_f32_16x16x32_bf16 v[72:75], v[244:247], v[192:195], v[72:75]
    ds_read_b64_tr_b16 v[242:243], v104 offset:9216
    v_mfma_f32_16x16x32_bf16 v[76:79], v[244:247], v[196:199], v[76:79]
    ds_read_b64_tr_b16 v[244:245], v105 offset:8192
    v_mfma_f32_16x16x32_bf16 v[80:83], v[248:251], v[192:195], v[80:83]
    ds_read_b64_tr_b16 v[246:247], v105 offset:9216
    v_mfma_f32_16x16x32_bf16 v[84:87], v[248:251], v[196:199], v[84:87]
    ds_read_b64_tr_b16 v[248:249], v106 offset:8192
    v_mfma_f32_16x16x32_bf16 v[88:91], v[252:255], v[192:195], v[88:91]
    ds_read_b64_tr_b16 v[250:251], v106 offset:9216
    v_mfma_f32_16x16x32_bf16 v[92:95], v[252:255], v[196:199], v[92:95]
    ds_read_b64_tr_b16 v[252:253], v107 offset:8192
    ds_read_b64_tr_b16 v[254:255], v107 offset:9216
    s_waitcnt lgkmcnt(0)
    s_barrier
    v_mfma_f32_16x16x32_bf16 v[32:35], v[224:227], v[200:203], v[32:35]
    ds_read_b128 v[192:195], v96 offset:16384
    v_mfma_f32_16x16x32_bf16 v[36:39], v[224:227], v[204:207], v[36:39]
    ds_read_b64_tr_b16 v[224:225], v100 offset:16384
    v_mfma_f32_16x16x32_bf16 v[40:43], v[228:231], v[200:203], v[40:43]
    ds_read_b64_tr_b16 v[226:227], v100 offset:17408
    ds_read_b128 v[196:199], v97 offset:16384
    v_mfma_f32_16x16x32_bf16 v[44:47], v[228:231], v[204:207], v[44:47]
    ds_read_b64_tr_b16 v[228:229], v101 offset:16384
    v_mfma_f32_16x16x32_bf16 v[48:51], v[232:235], v[200:203], v[48:51]
    ds_read_b64_tr_b16 v[230:231], v101 offset:17408
    v_mfma_f32_16x16x32_bf16 v[52:55], v[232:235], v[204:207], v[52:55]
    ds_read_b64_tr_b16 v[232:233], v102 offset:16384
    v_mfma_f32_16x16x32_bf16 v[56:59], v[236:239], v[200:203], v[56:59]
    ds_read_b64_tr_b16 v[234:235], v102 offset:17408
    v_mfma_f32_16x16x32_bf16 v[60:63], v[236:239], v[204:207], v[60:63]
    ds_read_b64_tr_b16 v[236:237], v103 offset:16384
    v_mfma_f32_16x16x32_bf16 v[64:67], v[240:243], v[200:203], v[64:67]
    ds_read_b64_tr_b16 v[238:239], v103 offset:17408
    v_mfma_f32_16x16x32_bf16 v[68:71], v[240:243], v[204:207], v[68:71]
    ds_read_b64_tr_b16 v[240:241], v104 offset:16384
    v_mfma_f32_16x16x32_bf16 v[72:75], v[244:247], v[200:203], v[72:75]
    ds_read_b64_tr_b16 v[242:243], v104 offset:17408
    v_mfma_f32_16x16x32_bf16 v[76:79], v[244:247], v[204:207], v[76:79]
    ds_read_b64_tr_b16 v[244:245], v105 offset:16384
    v_mfma_f32_16x16x32_bf16 v[80:83], v[248:251], v[200:203], v[80:83]
    ds_read_b64_tr_b16 v[246:247], v105 offset:17408
    v_mfma_f32_16x16x32_bf16 v[84:87], v[248:251], v[204:207], v[84:87]
    ds_read_b64_tr_b16 v[248:249], v106 offset:16384
    v_mfma_f32_16x16x32_bf16 v[88:91], v[252:255], v[200:203], v[88:91]
    ds_read_b64_tr_b16 v[250:251], v106 offset:17408
    v_mfma_f32_16x16x32_bf16 v[92:95], v[252:255], v[204:207], v[92:95]
    ds_read_b64_tr_b16 v[252:253], v107 offset:16384
    s_waitcnt lgkmcnt(10)
    v_mfma_f32_16x16x32_bf16 v[32:35], v[224:227], v[192:195], v[32:35]
    ds_read_b64_tr_b16 v[254:255], v107 offset:17408
    ds_read_b128 v[200:203], v98 offset:16384
    v_mfma_f32_16x16x32_bf16 v[36:39], v[224:227], v[196:199], v[36:39]
    ds_read_b64_tr_b16 v[224:225], v100 offset:24576
    v_mfma_f32_16x16x32_bf16 v[40:43], v[228:231], v[192:195], v[40:43]
    ds_read_b64_tr_b16 v[226:227], v100 offset:25600
    ds_read_b128 v[204:207], v99 offset:16384
    v_mfma_f32_16x16x32_bf16 v[44:47], v[228:231], v[196:199], v[44:47]
    ds_read_b64_tr_b16 v[228:229], v101 offset:24576
    s_waitcnt lgkmcnt(11)
    v_mfma_f32_16x16x32_bf16 v[48:51], v[232:235], v[192:195], v[48:51]
    ds_read_b64_tr_b16 v[230:231], v101 offset:25600
    v_mfma_f32_16x16x32_bf16 v[52:55], v[232:235], v[196:199], v[52:55]
    ds_read_b64_tr_b16 v[232:233], v102 offset:24576
    v_mfma_f32_16x16x32_bf16 v[56:59], v[236:239], v[192:195], v[56:59]
    ds_read_b64_tr_b16 v[234:235], v102 offset:25600
    v_mfma_f32_16x16x32_bf16 v[60:63], v[236:239], v[196:199], v[60:63]
    ds_read_b64_tr_b16 v[236:237], v103 offset:24576
    v_mfma_f32_16x16x32_bf16 v[64:67], v[240:243], v[192:195], v[64:67]
    ds_read_b64_tr_b16 v[238:239], v103 offset:25600
    v_mfma_f32_16x16x32_bf16 v[68:71], v[240:243], v[196:199], v[68:71]
    ds_read_b64_tr_b16 v[240:241], v104 offset:24576
    s_waitcnt lgkmcnt(11)
    v_mfma_f32_16x16x32_bf16 v[72:75], v[244:247], v[192:195], v[72:75]
    ds_read_b64_tr_b16 v[242:243], v104 offset:25600
    v_mfma_f32_16x16x32_bf16 v[76:79], v[244:247], v[196:199], v[76:79]
    ds_read_b64_tr_b16 v[244:245], v105 offset:24576
    v_mfma_f32_16x16x32_bf16 v[80:83], v[248:251], v[192:195], v[80:83]
    ds_read_b64_tr_b16 v[246:247], v105 offset:25600
    v_mfma_f32_16x16x32_bf16 v[84:87], v[248:251], v[196:199], v[84:87]
    ds_read_b64_tr_b16 v[248:249], v106 offset:24576
    v_mfma_f32_16x16x32_bf16 v[88:91], v[252:255], v[192:195], v[88:91]
    ds_read_b64_tr_b16 v[250:251], v106 offset:25600
    v_mfma_f32_16x16x32_bf16 v[92:95], v[252:255], v[196:199], v[92:95]
    ds_read_b64_tr_b16 v[252:253], v107 offset:24576
    ds_read_b64_tr_b16 v[254:255], v107 offset:25600
    s_waitcnt lgkmcnt(0)
    s_barrier
    v_mfma_f32_16x16x32_bf16 v[32:35], v[224:227], v[200:203], v[32:35]
    ds_read_b128 v[192:195], v96 offset:32768
    v_mfma_f32_16x16x32_bf16 v[36:39], v[224:227], v[204:207], v[36:39]
    ds_read_b64_tr_b16 v[224:225], v100 offset:32768
    v_mfma_f32_16x16x32_bf16 v[40:43], v[228:231], v[200:203], v[40:43]
    ds_read_b64_tr_b16 v[226:227], v100 offset:33792
    ds_read_b128 v[196:199], v97 offset:32768
    v_mfma_f32_16x16x32_bf16 v[44:47], v[228:231], v[204:207], v[44:47]
    ds_read_b64_tr_b16 v[228:229], v101 offset:32768
    v_mfma_f32_16x16x32_bf16 v[48:51], v[232:235], v[200:203], v[48:51]
    ds_read_b64_tr_b16 v[230:231], v101 offset:33792
    v_mfma_f32_16x16x32_bf16 v[52:55], v[232:235], v[204:207], v[52:55]
    ds_read_b64_tr_b16 v[232:233], v102 offset:32768
    v_mfma_f32_16x16x32_bf16 v[56:59], v[236:239], v[200:203], v[56:59]
    ds_read_b64_tr_b16 v[234:235], v102 offset:33792
    v_mfma_f32_16x16x32_bf16 v[60:63], v[236:239], v[204:207], v[60:63]
    ds_read_b64_tr_b16 v[236:237], v103 offset:32768
    v_mfma_f32_16x16x32_bf16 v[64:67], v[240:243], v[200:203], v[64:67]
    ds_read_b64_tr_b16 v[238:239], v103 offset:33792
    v_mfma_f32_16x16x32_bf16 v[68:71], v[240:243], v[204:207], v[68:71]
    ds_read_b64_tr_b16 v[240:241], v104 offset:32768
    v_mfma_f32_16x16x32_bf16 v[72:75], v[244:247], v[200:203], v[72:75]
    ds_read_b64_tr_b16 v[242:243], v104 offset:33792
    v_mfma_f32_16x16x32_bf16 v[76:79], v[244:247], v[204:207], v[76:79]
    ds_read_b64_tr_b16 v[244:245], v105 offset:32768
    v_mfma_f32_16x16x32_bf16 v[80:83], v[248:251], v[200:203], v[80:83]
    ds_read_b64_tr_b16 v[246:247], v105 offset:33792
    v_mfma_f32_16x16x32_bf16 v[84:87], v[248:251], v[204:207], v[84:87]
    ds_read_b64_tr_b16 v[248:249], v106 offset:32768
    v_mfma_f32_16x16x32_bf16 v[88:91], v[252:255], v[200:203], v[88:91]
    ds_read_b64_tr_b16 v[250:251], v106 offset:33792
    v_mfma_f32_16x16x32_bf16 v[92:95], v[252:255], v[204:207], v[92:95]
    ds_read_b64_tr_b16 v[252:253], v107 offset:32768
    s_waitcnt lgkmcnt(10)
    v_mfma_f32_16x16x32_bf16 v[32:35], v[224:227], v[192:195], v[32:35]
    ds_read_b64_tr_b16 v[254:255], v107 offset:33792
    ds_read_b128 v[200:203], v98 offset:32768
    v_mfma_f32_16x16x32_bf16 v[36:39], v[224:227], v[196:199], v[36:39]
    ds_read_b64_tr_b16 v[224:225], v100 offset:40960
    v_mfma_f32_16x16x32_bf16 v[40:43], v[228:231], v[192:195], v[40:43]
    ds_read_b64_tr_b16 v[226:227], v100 offset:41984
    ds_read_b128 v[204:207], v99 offset:32768
    v_mfma_f32_16x16x32_bf16 v[44:47], v[228:231], v[196:199], v[44:47]
    ds_read_b64_tr_b16 v[228:229], v101 offset:40960
    s_waitcnt lgkmcnt(11)
    v_mfma_f32_16x16x32_bf16 v[48:51], v[232:235], v[192:195], v[48:51]
    ds_read_b64_tr_b16 v[230:231], v101 offset:41984
    v_mfma_f32_16x16x32_bf16 v[52:55], v[232:235], v[196:199], v[52:55]
    ds_read_b64_tr_b16 v[232:233], v102 offset:40960
    v_mfma_f32_16x16x32_bf16 v[56:59], v[236:239], v[192:195], v[56:59]
    ds_read_b64_tr_b16 v[234:235], v102 offset:41984
    v_mfma_f32_16x16x32_bf16 v[60:63], v[236:239], v[196:199], v[60:63]
    ds_read_b64_tr_b16 v[236:237], v103 offset:40960
    v_mfma_f32_16x16x32_bf16 v[64:67], v[240:243], v[192:195], v[64:67]
    ds_read_b64_tr_b16 v[238:239], v103 offset:41984
    v_mfma_f32_16x16x32_bf16 v[68:71], v[240:243], v[196:199], v[68:71]
    ds_read_b64_tr_b16 v[240:241], v104 offset:40960
    s_waitcnt lgkmcnt(11)
    v_mfma_f32_16x16x32_bf16 v[72:75], v[244:247], v[192:195], v[72:75]
    ds_read_b64_tr_b16 v[242:243], v104 offset:41984
    v_mfma_f32_16x16x32_bf16 v[76:79], v[244:247], v[196:199], v[76:79]
    ds_read_b64_tr_b16 v[244:245], v105 offset:40960
    v_mfma_f32_16x16x32_bf16 v[80:83], v[248:251], v[192:195], v[80:83]
    ds_read_b64_tr_b16 v[246:247], v105 offset:41984
    v_mfma_f32_16x16x32_bf16 v[84:87], v[248:251], v[196:199], v[84:87]
    ds_read_b64_tr_b16 v[248:249], v106 offset:40960
    v_mfma_f32_16x16x32_bf16 v[88:91], v[252:255], v[192:195], v[88:91]
    ds_read_b64_tr_b16 v[250:251], v106 offset:41984
    v_mfma_f32_16x16x32_bf16 v[92:95], v[252:255], v[196:199], v[92:95]
    ds_read_b64_tr_b16 v[252:253], v107 offset:40960
    ds_read_b64_tr_b16 v[254:255], v107 offset:41984
    s_waitcnt lgkmcnt(0)
    s_barrier
    v_mfma_f32_16x16x32_bf16 v[32:35], v[224:227], v[200:203], v[32:35]
    ds_read_b128 v[192:195], v96 offset:49152
    v_mfma_f32_16x16x32_bf16 v[36:39], v[224:227], v[204:207], v[36:39]
    ds_read_b64_tr_b16 v[224:225], v100 offset:49152
    v_mfma_f32_16x16x32_bf16 v[40:43], v[228:231], v[200:203], v[40:43]
    ds_read_b64_tr_b16 v[226:227], v100 offset:50176
    ds_read_b128 v[196:199], v97 offset:49152
    v_mfma_f32_16x16x32_bf16 v[44:47], v[228:231], v[204:207], v[44:47]
    ds_read_b64_tr_b16 v[228:229], v101 offset:49152
    v_mfma_f32_16x16x32_bf16 v[48:51], v[232:235], v[200:203], v[48:51]
    ds_read_b64_tr_b16 v[230:231], v101 offset:50176
    v_mfma_f32_16x16x32_bf16 v[52:55], v[232:235], v[204:207], v[52:55]
    ds_read_b64_tr_b16 v[232:233], v102 offset:49152
    v_mfma_f32_16x16x32_bf16 v[56:59], v[236:239], v[200:203], v[56:59]
    ds_read_b64_tr_b16 v[234:235], v102 offset:50176
    v_mfma_f32_16x16x32_bf16 v[60:63], v[236:239], v[204:207], v[60:63]
    ds_read_b64_tr_b16 v[236:237], v103 offset:49152
    v_mfma_f32_16x16x32_bf16 v[64:67], v[240:243], v[200:203], v[64:67]
    ds_read_b64_tr_b16 v[238:239], v103 offset:50176
    v_mfma_f32_16x16x32_bf16 v[68:71], v[240:243], v[204:207], v[68:71]
    ds_read_b64_tr_b16 v[240:241], v104 offset:49152
    v_mfma_f32_16x16x32_bf16 v[72:75], v[244:247], v[200:203], v[72:75]
    ds_read_b64_tr_b16 v[242:243], v104 offset:50176
    v_mfma_f32_16x16x32_bf16 v[76:79], v[244:247], v[204:207], v[76:79]
    ds_read_b64_tr_b16 v[244:245], v105 offset:49152
    v_mfma_f32_16x16x32_bf16 v[80:83], v[248:251], v[200:203], v[80:83]
    ds_read_b64_tr_b16 v[246:247], v105 offset:50176
    v_mfma_f32_16x16x32_bf16 v[84:87], v[248:251], v[204:207], v[84:87]
    ds_read_b64_tr_b16 v[248:249], v106 offset:49152
    v_mfma_f32_16x16x32_bf16 v[88:91], v[252:255], v[200:203], v[88:91]
    ds_read_b64_tr_b16 v[250:251], v106 offset:50176
    v_mfma_f32_16x16x32_bf16 v[92:95], v[252:255], v[204:207], v[92:95]
    ds_read_b64_tr_b16 v[252:253], v107 offset:49152
    s_waitcnt lgkmcnt(10)
    v_mfma_f32_16x16x32_bf16 v[32:35], v[224:227], v[192:195], v[32:35]
    ds_read_b64_tr_b16 v[254:255], v107 offset:50176
    ds_read_b128 v[200:203], v98 offset:49152
    v_mfma_f32_16x16x32_bf16 v[36:39], v[224:227], v[196:199], v[36:39]
    ds_read_b64_tr_b16 v[224:225], v100 offset:57344
    v_mfma_f32_16x16x32_bf16 v[40:43], v[228:231], v[192:195], v[40:43]
    ds_read_b64_tr_b16 v[226:227], v100 offset:58368
    ds_read_b128 v[204:207], v99 offset:49152
    v_mfma_f32_16x16x32_bf16 v[44:47], v[228:231], v[196:199], v[44:47]
    ds_read_b64_tr_b16 v[228:229], v101 offset:57344
    s_waitcnt lgkmcnt(11)
    v_mfma_f32_16x16x32_bf16 v[48:51], v[232:235], v[192:195], v[48:51]
    ds_read_b64_tr_b16 v[230:231], v101 offset:58368
    v_mfma_f32_16x16x32_bf16 v[52:55], v[232:235], v[196:199], v[52:55]
    ds_read_b64_tr_b16 v[232:233], v102 offset:57344
    v_mfma_f32_16x16x32_bf16 v[56:59], v[236:239], v[192:195], v[56:59]
    ds_read_b64_tr_b16 v[234:235], v102 offset:58368
    v_mfma_f32_16x16x32_bf16 v[60:63], v[236:239], v[196:199], v[60:63]
    ds_read_b64_tr_b16 v[236:237], v103 offset:57344
    v_mfma_f32_16x16x32_bf16 v[64:67], v[240:243], v[192:195], v[64:67]
    ds_read_b64_tr_b16 v[238:239], v103 offset:58368
    v_mfma_f32_16x16x32_bf16 v[68:71], v[240:243], v[196:199], v[68:71]
    ds_read_b64_tr_b16 v[240:241], v104 offset:57344
    s_waitcnt lgkmcnt(11)
    v_mfma_f32_16x16x32_bf16 v[72:75], v[244:247], v[192:195], v[72:75]
    ds_read_b64_tr_b16 v[242:243], v104 offset:58368
    v_mfma_f32_16x16x32_bf16 v[76:79], v[244:247], v[196:199], v[76:79]
    ds_read_b64_tr_b16 v[244:245], v105 offset:57344
    v_mfma_f32_16x16x32_bf16 v[80:83], v[248:251], v[192:195], v[80:83]
    ds_read_b64_tr_b16 v[246:247], v105 offset:58368
    v_mfma_f32_16x16x32_bf16 v[84:87], v[248:251], v[196:199], v[84:87]
    ds_read_b64_tr_b16 v[248:249], v106 offset:57344
    v_mfma_f32_16x16x32_bf16 v[88:91], v[252:255], v[192:195], v[88:91]
    ds_read_b64_tr_b16 v[250:251], v106 offset:58368
    v_mfma_f32_16x16x32_bf16 v[92:95], v[252:255], v[196:199], v[92:95]
    ds_read_b64_tr_b16 v[252:253], v107 offset:57344
    ds_read_b64_tr_b16 v[254:255], v107 offset:58368
    s_waitcnt lgkmcnt(0)
    s_barrier
    v_mfma_f32_16x16x32_bf16 v[32:35], v[224:227], v[200:203], v[32:35]
    v_mfma_f32_16x16x32_bf16 v[36:39], v[224:227], v[204:207], v[36:39]
    ds_read_b128 v[224:227], v208 offset:0
    v_mfma_f32_16x16x32_bf16 v[40:43], v[228:231], v[200:203], v[40:43]
    v_mfma_f32_16x16x32_bf16 v[44:47], v[228:231], v[204:207], v[44:47]
    ds_read_b128 v[228:231], v209 offset:0
    v_mfma_f32_16x16x32_bf16 v[48:51], v[232:235], v[200:203], v[48:51]
    v_mfma_f32_16x16x32_bf16 v[52:55], v[232:235], v[204:207], v[52:55]
    ds_read_b128 v[232:235], v210 offset:0
    v_mfma_f32_16x16x32_bf16 v[56:59], v[236:239], v[200:203], v[56:59]
    v_mfma_f32_16x16x32_bf16 v[60:63], v[236:239], v[204:207], v[60:63]
    ds_read_b128 v[236:239], v211 offset:0
    v_mfma_f32_16x16x32_bf16 v[64:67], v[240:243], v[200:203], v[64:67]
    v_mfma_f32_16x16x32_bf16 v[68:71], v[240:243], v[204:207], v[68:71]
    ds_read_b128 v[240:243], v212 offset:0
    v_mfma_f32_16x16x32_bf16 v[72:75], v[244:247], v[200:203], v[72:75]
    v_mfma_f32_16x16x32_bf16 v[76:79], v[244:247], v[204:207], v[76:79]
    ds_read_b128 v[244:247], v213 offset:0
    v_mfma_f32_16x16x32_bf16 v[80:83], v[248:251], v[200:203], v[80:83]
    v_mfma_f32_16x16x32_bf16 v[84:87], v[248:251], v[204:207], v[84:87]
    ds_read_b128 v[248:251], v214 offset:0
    v_mfma_f32_16x16x32_bf16 v[88:91], v[252:255], v[200:203], v[88:91]
    v_mfma_f32_16x16x32_bf16 v[92:95], v[252:255], v[204:207], v[92:95]
    ds_read_b128 v[252:255], v215 offset:0
    v_cvt_pk_bf16_f32 v160, v32, v33
    v_cvt_pk_bf16_f32 v161, v34, v35
    v_cvt_pk_bf16_f32 v162, v36, v37
    v_cvt_pk_bf16_f32 v163, v38, v39
    v_cvt_pk_bf16_f32 v164, v40, v41
    v_cvt_pk_bf16_f32 v165, v42, v43
    v_cvt_pk_bf16_f32 v166, v44, v45
    v_cvt_pk_bf16_f32 v167, v46, v47
    v_permlane16_swap_b32 v160, v162
    v_permlane16_swap_b32 v161, v163
    v_permlane16_swap_b32 v164, v166
    v_permlane16_swap_b32 v165, v167
    s_waitcnt lgkmcnt(4)
    v_mfma_f32_32x32x16_bf16 v[96:111], v[224:227], v[160:163], 0
    v_cvt_pk_bf16_f32 v168, v48, v49
    v_cvt_pk_bf16_f32 v169, v50, v51
    v_cvt_pk_bf16_f32 v170, v52, v53
    v_cvt_pk_bf16_f32 v171, v54, v55
    v_cvt_pk_bf16_f32 v172, v56, v57
    v_cvt_pk_bf16_f32 v173, v58, v59
    v_cvt_pk_bf16_f32 v174, v60, v61
    v_cvt_pk_bf16_f32 v175, v62, v63
    v_permlane16_swap_b32 v168, v170
    v_permlane16_swap_b32 v169, v171
    v_permlane16_swap_b32 v172, v174
    v_permlane16_swap_b32 v173, v175
    ds_read_b128 v[224:227], v208 offset:8192
    v_mfma_f32_32x32x16_bf16 v[96:111], v[228:231], v[164:167], v[96:111]
    ds_read_b128 v[228:231], v209 offset:8192
    v_mfma_f32_32x32x16_bf16 v[96:111], v[232:235], v[168:171], v[96:111]
    v_cvt_pk_bf16_f32 v176, v64, v65
    v_cvt_pk_bf16_f32 v177, v66, v67
    v_cvt_pk_bf16_f32 v178, v68, v69
    v_cvt_pk_bf16_f32 v179, v70, v71
    v_cvt_pk_bf16_f32 v180, v72, v73
    v_cvt_pk_bf16_f32 v181, v74, v75
    v_cvt_pk_bf16_f32 v182, v76, v77
    v_cvt_pk_bf16_f32 v183, v78, v79
    v_permlane16_swap_b32 v176, v178
    v_permlane16_swap_b32 v177, v179
    v_permlane16_swap_b32 v180, v182
    v_permlane16_swap_b32 v181, v183
    ds_read_b128 v[232:235], v210 offset:8192
    v_mfma_f32_32x32x16_bf16 v[96:111], v[236:239], v[172:175], v[96:111]
    ds_read_b128 v[236:239], v211 offset:8192
    s_waitcnt lgkmcnt(4)
    v_mfma_f32_32x32x16_bf16 v[96:111], v[240:243], v[176:179], v[96:111]
    v_cvt_pk_bf16_f32 v184, v80, v81
    v_cvt_pk_bf16_f32 v185, v82, v83
    v_cvt_pk_bf16_f32 v186, v84, v85
    v_cvt_pk_bf16_f32 v187, v86, v87
    v_cvt_pk_bf16_f32 v188, v88, v89
    v_cvt_pk_bf16_f32 v189, v90, v91
    v_cvt_pk_bf16_f32 v190, v92, v93
    v_cvt_pk_bf16_f32 v191, v94, v95
    v_permlane16_swap_b32 v184, v186
    v_permlane16_swap_b32 v185, v187
    v_permlane16_swap_b32 v188, v190
    v_permlane16_swap_b32 v189, v191
    ds_read_b128 v[240:243], v212 offset:8192
    v_mfma_f32_32x32x16_bf16 v[96:111], v[244:247], v[180:183], v[96:111]
    ds_read_b128 v[244:247], v213 offset:8192
    v_mfma_f32_32x32x16_bf16 v[96:111], v[248:251], v[184:187], v[96:111]
    ds_read_b128 v[248:251], v214 offset:8192
    v_mfma_f32_32x32x16_bf16 v[96:111], v[252:255], v[188:191], v[96:111]
    ds_read_b128 v[252:255], v215 offset:8192
    s_waitcnt lgkmcnt(4)
    v_mfma_f32_32x32x16_bf16 v[112:127], v[224:227], v[160:163], 0
    ds_read_b128 v[224:227], v208 offset:16384
    v_mfma_f32_32x32x16_bf16 v[112:127], v[228:231], v[164:167], v[112:127]
    ds_read_b128 v[228:231], v209 offset:16384
    v_mfma_f32_32x32x16_bf16 v[112:127], v[232:235], v[168:171], v[112:127]
    ds_read_b128 v[232:235], v210 offset:16384
    s_nop 3
    v_max_f32 v20, v96, v97
    v_max3_f32 v20, v98, v99, v20
    v_max3_f32 v20, v100, v101, v20
    v_max3_f32 v20, v102, v103, v20
    v_max3_f32 v20, v104, v105, v20
    v_max3_f32 v20, v106, v107, v20
    v_mfma_f32_32x32x16_bf16 v[112:127], v[236:239], v[172:175], v[112:127]
    ds_read_b128 v[236:239], v211 offset:16384
    v_max3_f32 v20, v108, v109, v20
    v_max3_f32 v20, v110, v111, v20
    v_mul_f32 v4, s48, v20
    v_fma_f32 v96, v96, s48, -v4
    v_fma_f32 v97, v97, s48, -v4
    v_fma_f32 v98, v98, s48, -v4
    s_waitcnt lgkmcnt(4)
    v_mfma_f32_32x32x16_bf16 v[112:127], v[240:243], v[176:179], v[112:127]
    ds_read_b128 v[240:243], v212 offset:16384
    v_exp_f32 v96, v96
    v_fma_f32 v99, v99, s48, -v4
    v_exp_f32 v97, v97
    v_fma_f32 v100, v100, s48, -v4
    v_exp_f32 v98, v98
    v_fma_f32 v101, v101, s48, -v4
    v_mfma_f32_32x32x16_bf16 v[112:127], v[244:247], v[180:183], v[112:127]
    ds_read_b128 v[244:247], v213 offset:16384
    v_add_f32 v32, v96, v97
    v_exp_f32 v99, v99
    v_fma_f32 v102, v102, s48, -v4
    v_add_f32 v32, v32, v98
    v_exp_f32 v100, v100
    v_fma_f32 v103, v103, s48, -v4
    v_mfma_f32_32x32x16_bf16 v[112:127], v[248:251], v[184:187], v[112:127]
    ds_read_b128 v[248:251], v214 offset:16384
    v_add_f32 v32, v32, v99
    v_exp_f32 v101, v101
    v_fma_f32 v104, v104, s48, -v4
    v_add_f32 v32, v32, v100
    v_exp_f32 v102, v102
    v_fma_f32 v105, v105, s48, -v4
    v_mfma_f32_32x32x16_bf16 v[112:127], v[252:255], v[188:191], v[112:127]
    ds_read_b128 v[252:255], v215 offset:16384
    v_add_f32 v32, v32, v101
    v_exp_f32 v103, v103
    v_fma_f32 v106, v106, s48, -v4
    v_add_f32 v32, v32, v102
    v_exp_f32 v104, v104
    v_fma_f32 v107, v107, s48, -v4
    s_waitcnt lgkmcnt(4)
    v_mfma_f32_32x32x16_bf16 v[128:143], v[224:227], v[160:163], 0
    ds_read_b128 v[224:227], v208 offset:24576
    v_add_f32 v32, v32, v103
    v_exp_f32 v105, v105
    v_fma_f32 v108, v108, s48, -v4
    v_add_f32 v32, v32, v104
    v_exp_f32 v106, v106
    v_fma_f32 v109, v109, s48, -v4
    v_mfma_f32_32x32x16_bf16 v[128:143], v[228:231], v[164:167], v[128:143]
    ds_read_b128 v[228:231], v209 offset:24576
    v_add_f32 v32, v32, v105
    v_exp_f32 v107, v107
    v_fma_f32 v110, v110, s48, -v4
    v_add_f32 v32, v32, v106
    v_exp_f32 v108, v108
    v_fma_f32 v111, v111, s48, -v4
    v_mfma_f32_32x32x16_bf16 v[128:143], v[232:235], v[168:171], v[128:143]
    ds_read_b128 v[232:235], v210 offset:24576
    v_add_f32 v32, v32, v107
    v_exp_f32 v109, v109
    v_add_f32 v32, v32, v108
    v_exp_f32 v110, v110
    v_add_f32 v32, v32, v109
    v_exp_f32 v111, v111
    v_mfma_f32_32x32x16_bf16 v[128:143], v[236:239], v[172:175], v[128:143]
    ds_read_b128 v[236:239], v211 offset:24576
    v_add_f32 v32, v32, v110
    v_add_f32 v32, v32, v111
    v_max3_f32 v20, v112, v113, v20
    v_max3_f32 v20, v114, v115, v20
    v_max3_f32 v20, v116, v117, v20
    v_max3_f32 v20, v118, v119, v20
    s_waitcnt lgkmcnt(4)
    v_mfma_f32_32x32x16_bf16 v[128:143], v[240:243], v[176:179], v[128:143]
    ds_read_b128 v[240:243], v212 offset:24576
    v_max3_f32 v20, v120, v121, v20
    v_max3_f32 v20, v122, v123, v20
    v_max3_f32 v20, v124, v125, v20
    v_max3_f32 v20, v126, v127, v20
    v_mul_f32 v5, s48, v20
    v_fma_f32 v112, v112, s48, -v5
    v_mfma_f32_32x32x16_bf16 v[128:143], v[244:247], v[180:183], v[128:143]
    ds_read_b128 v[244:247], v213 offset:24576
    v_fma_f32 v113, v113, s48, -v5
    v_fma_f32 v114, v114, s48, -v5
    v_exp_f32 v112, v112
    v_fma_f32 v115, v115, s48, -v5
    v_exp_f32 v113, v113
    v_fma_f32 v116, v116, s48, -v5
    v_mfma_f32_32x32x16_bf16 v[128:143], v[248:251], v[184:187], v[128:143]
    ds_read_b128 v[248:251], v214 offset:24576
    v_exp_f32 v114, v114
    v_fma_f32 v117, v117, s48, -v5
    v_add_f32 v33, v112, v113
    v_exp_f32 v115, v115
    v_fma_f32 v118, v118, s48, -v5
    v_add_f32 v33, v33, v114
    v_mfma_f32_32x32x16_bf16 v[128:143], v[252:255], v[188:191], v[128:143]
    ds_read_b128 v[252:255], v215 offset:24576
    v_exp_f32 v116, v116
    v_fma_f32 v119, v119, s48, -v5
    v_add_f32 v33, v33, v115
    v_exp_f32 v117, v117
    v_fma_f32 v120, v120, s48, -v5
    v_add_f32 v33, v33, v116
    s_waitcnt lgkmcnt(4)
    v_mfma_f32_32x32x16_bf16 v[144:159], v[224:227], v[160:163], 0
    v_exp_f32 v118, v118
    v_fma_f32 v121, v121, s48, -v5
    v_add_f32 v33, v33, v117
    v_exp_f32 v119, v119
    v_fma_f32 v122, v122, s48, -v5
    v_add_f32 v33, v33, v118
    v_mfma_f32_32x32x16_bf16 v[144:159], v[228:231], v[164:167], v[144:159]
    v_exp_f32 v120, v120
    v_fma_f32 v123, v123, s48, -v5
    v_add_f32 v33, v33, v119
    v_exp_f32 v121, v121
    v_fma_f32 v124, v124, s48, -v5
    v_add_f32 v33, v33, v120
    v_mfma_f32_32x32x16_bf16 v[144:159], v[232:235], v[168:171], v[144:159]
    v_exp_f32 v122, v122
    v_fma_f32 v125, v125, s48, -v5
    v_add_f32 v33, v33, v121
    v_exp_f32 v123, v123
    v_fma_f32 v126, v126, s48, -v5
    v_add_f32 v33, v33, v122
    v_mfma_f32_32x32x16_bf16 v[144:159], v[236:239], v[172:175], v[144:159]
    v_exp_f32 v124, v124
    v_fma_f32 v127, v127, s48, -v5
    v_add_f32 v33, v33, v123
    v_exp_f32 v125, v125
    v_add_f32 v33, v33, v124
    v_exp_f32 v126, v126
    s_waitcnt lgkmcnt(3)
    v_mfma_f32_32x32x16_bf16 v[144:159], v[240:243], v[176:179], v[144:159]
    v_add_f32 v33, v33, v125
    v_exp_f32 v127, v127
    v_add_f32 v33, v33, v126
    v_add_f32 v33, v33, v127
    v_max3_f32 v20, v128, v129, v20
    v_max3_f32 v20, v130, v131, v20
    s_waitcnt lgkmcnt(2)
    v_mfma_f32_32x32x16_bf16 v[144:159], v[244:247], v[180:183], v[144:159]
    v_max3_f32 v20, v132, v133, v20
    v_max3_f32 v20, v134, v135, v20
    v_max3_f32 v20, v136, v137, v20
    v_max3_f32 v20, v138, v139, v20
    v_max3_f32 v20, v140, v141, v20
    v_max3_f32 v20, v142, v143, v20
    s_waitcnt lgkmcnt(1)
    v_mfma_f32_32x32x16_bf16 v[144:159], v[248:251], v[184:187], v[144:159]
    v_mul_f32 v6, s48, v20
    v_fma_f32 v128, v128, s48, -v6
    v_fma_f32 v129, v129, s48, -v6
    v_fma_f32 v130, v130, s48, -v6
    v_exp_f32 v128, v128
    v_fma_f32 v131, v131, s48, -v6
    s_waitcnt lgkmcnt(0)
    v_mfma_f32_32x32x16_bf16 v[144:159], v[252:255], v[188:191], v[144:159]
    v_exp_f32 v129, v129
    v_fma_f32 v132, v132, s48, -v6
    v_exp_f32 v130, v130
    v_fma_f32 v133, v133, s48, -v6
    v_add_f32 v34, v128, v129
    v_exp_f32 v131, v131
    v_fma_f32 v134, v134, s48, -v6
    v_add_f32 v34, v34, v130
    v_exp_f32 v132, v132
    v_fma_f32 v135, v135, s48, -v6
    v_add_f32 v34, v34, v131
    v_exp_f32 v133, v133
    v_fma_f32 v136, v136, s48, -v6
    v_add_f32 v34, v34, v132
    v_exp_f32 v134, v134
    v_fma_f32 v137, v137, s48, -v6
    v_add_f32 v34, v34, v133
    v_exp_f32 v135, v135
    v_fma_f32 v138, v138, s48, -v6
    v_add_f32 v34, v34, v134
    v_exp_f32 v136, v136
    v_fma_f32 v139, v139, s48, -v6
    v_add_f32 v34, v34, v135
    v_exp_f32 v137, v137
    v_fma_f32 v140, v140, s48, -v6
    v_add_f32 v34, v34, v136
    v_exp_f32 v138, v138
    v_fma_f32 v141, v141, s48, -v6
    v_add_f32 v34, v34, v137
    v_exp_f32 v139, v139
    v_fma_f32 v142, v142, s48, -v6
    v_add_f32 v34, v34, v138
    v_exp_f32 v140, v140
    v_fma_f32 v143, v143, s48, -v6
    v_add_f32 v34, v34, v139
    v_exp_f32 v141, v141
    v_add_f32 v34, v34, v140
    v_exp_f32 v142, v142
    v_add_f32 v34, v34, v141
    v_exp_f32 v143, v143
    v_add_f32 v34, v34, v142
    v_add_f32 v34, v34, v143
    v_max3_f32 v20, v144, v145, v20
    v_max3_f32 v20, v146, v147, v20
    v_max3_f32 v20, v148, v149, v20
    v_max3_f32 v20, v150, v151, v20
    v_max3_f32 v20, v152, v153, v20
    v_max3_f32 v20, v154, v155, v20
    v_max3_f32 v20, v156, v157, v20
    v_max3_f32 v20, v158, v159, v20
    v_mul_f32 v7, s48, v20
    v_mov_b32 v40, s48
    v_mov_b32 v20, v7
    v_mov_b32 v41, s48
    v_sub_f32 v42, 0, v7
    v_sub_f32 v43, 0, v7
    v_mov_b32 v21, v7
    v_pk_fma_f32 v[144:145], v[144:145], v[40:41], v[42:43]
    v_pk_fma_f32 v[146:147], v[146:147], v[40:41], v[42:43]
    v_exp_f32 v144, v144
    v_exp_f32 v145, v145
    v_permlane32_swap_b32 v20, v21
    v_pk_fma_f32 v[148:149], v[148:149], v[40:41], v[42:43]
    v_exp_f32 v146, v146
    v_exp_f32 v147, v147
    v_max_f32 v20, v20, v21
    v_pk_fma_f32 v[150:151], v[150:151], v[40:41], v[42:43]
    v_exp_f32 v148, v148
    v_exp_f32 v149, v149
    v_pk_fma_f32 v[152:153], v[152:153], v[40:41], v[42:43]
    v_sub_f32 v36, v4, v20
    v_pk_add_f32 v[44:45], v[144:145], v[146:147]
    v_exp_f32 v150, v150
    v_exp_f32 v151, v151
    v_sub_f32 v37, v5, v20
    s_barrier
    ds_read_b64_tr_b16 v[224:225], v8 offset:0
    ds_read_b64_tr_b16 v[226:227], v8 offset:2048
    ds_read_b64_tr_b16 v[228:229], v9 offset:0
    v_sub_f32 v38, v6, v20
    ds_read_b64_tr_b16 v[230:231], v9 offset:2048
    ds_read_b64_tr_b16 v[232:233], v10 offset:0
    ds_read_b64_tr_b16 v[234:235], v10 offset:2048
    v_sub_f32 v39, v7, v20
    ds_read_b64_tr_b16 v[236:237], v11 offset:0
    ds_read_b64_tr_b16 v[238:239], v11 offset:2048
    ds_read_b64_tr_b16 v[240:241], v8 offset:4096
    ds_read_b64_tr_b16 v[242:243], v8 offset:6144
    v_exp_f32 v36, v36
    ds_read_b64_tr_b16 v[244:245], v9 offset:4096
    ds_read_b64_tr_b16 v[246:247], v9 offset:6144
    ds_read_b64_tr_b16 v[248:249], v10 offset:4096
    v_exp_f32 v37, v37
    ds_read_b64_tr_b16 v[250:251], v10 offset:6144
    ds_read_b64_tr_b16 v[252:253], v11 offset:4096
    ds_read_b64_tr_b16 v[254:255], v11 offset:6144
    v_pk_fma_f32 v[154:155], v[154:155], v[40:41], v[42:43]
    v_exp_f32 v38, v38
    v_pk_add_f32 v[44:45], v[44:45], v[148:149]
    v_exp_f32 v152, v152
    v_exp_f32 v153, v153
    v_exp_f32 v39, v39
    v_pk_fma_f32 v[156:157], v[156:157], v[40:41], v[42:43]
    v_pk_add_f32 v[44:45], v[44:45], v[150:151]
    v_exp_f32 v154, v154
    v_exp_f32 v155, v155
    v_mul_f32 v22, v36, v32
    v_pk_fma_f32 v[158:159], v[158:159], v[40:41], v[42:43]
    v_pk_add_f32 v[44:45], v[44:45], v[152:153]
    v_exp_f32 v156, v156
    v_fmac_f32 v22, v37, v33
    v_exp_f32 v157, v157
    v_pk_add_f32 v[44:45], v[44:45], v[154:155]
    v_exp_f32 v158, v158
    v_exp_f32 v159, v159
    v_fmac_f32 v22, v38, v34
    v_pk_add_f32 v[44:45], v[44:45], v[156:157]
    v_pk_add_f32 v[44:45], v[44:45], v[158:159]
    v_add_f32 v35, v44, v45
    v_fmac_f32 v22, v39, v35
    v_mov_b32 v23, v22
    s_nop 1
    v_permlane32_swap_b32 v22, v23
    v_add_f32 v22, v22, v23
    v_rcp_f32 v22, v22
    s_nop 0
    v_mul_f32 v4, v36, v22
    v_mul_f32 v5, v37, v22
    v_mul_f32 v6, v38, v22
    v_mul_f32 v7, v39, v22
    global_load_dword v21, v31, s[16:17] sc1
    v_mul_f32 v96, v96, v4
    v_mul_f32 v97, v97, v4
    v_cvt_pk_bf16_f32 v192, v96, v97
    v_mul_f32 v98, v98, v4
    v_mul_f32 v99, v99, v4
    v_cvt_pk_bf16_f32 v193, v98, v99
    v_mul_f32 v100, v100, v4
    v_mul_f32 v101, v101, v4
    v_cvt_pk_bf16_f32 v194, v100, v101
    v_mul_f32 v102, v102, v4
    v_mul_f32 v103, v103, v4
    v_cvt_pk_bf16_f32 v195, v102, v103
    s_add_u32 s26, s60, 4096
    s_waitcnt lgkmcnt(8)
    v_mfma_f32_32x32x16_bf16 v[32:47], v[224:227], v[192:195], 0
    ds_read_b64_tr_b16 v[224:225], v8 offset:8192
    ds_read_b64_tr_b16 v[226:227], v8 offset:10240
    v_mul_f32 v104, v104, v4
    v_mul_f32 v105, v105, v4
    v_cvt_pk_bf16_f32 v196, v104, v105
    v_mul_f32 v106, v106, v4
    v_mul_f32 v107, v107, v4
    v_cvt_pk_bf16_f32 v197, v106, v107
    v_mfma_f32_32x32x16_bf16 v[48:63], v[228:231], v[192:195], 0
    ds_read_b64_tr_b16 v[228:229], v8 offset:12288
    ds_read_b64_tr_b16 v[230:231], v8 offset:14336
    v_mul_f32 v108, v108, v4
    v_mul_f32 v109, v109, v4
    v_cvt_pk_bf16_f32 v198, v108, v109
    v_mul_f32 v110, v110, v4
    v_mul_f32 v111, v111, v4
    v_cvt_pk_bf16_f32 v199, v110, v111
    v_mfma_f32_32x32x16_bf16 v[64:79], v[232:235], v[192:195], 0
    ds_read_b64_tr_b16 v[232:233], v8 offset:16384
    ds_read_b64_tr_b16 v[234:235], v8 offset:18432
    v_mul_f32 v112, v112, v5
    v_mul_f32 v113, v113, v5
    v_cvt_pk_bf16_f32 v200, v112, v113
    v_mul_f32 v114, v114, v5
    v_mul_f32 v115, v115, v5
    v_cvt_pk_bf16_f32 v201, v114, v115
    v_mfma_f32_32x32x16_bf16 v[80:95], v[236:239], v[192:195], 0
    ds_read_b64_tr_b16 v[236:237], v8 offset:20480
    ds_read_b64_tr_b16 v[238:239], v8 offset:22528
    v_mul_f32 v116, v116, v5
    v_mul_f32 v117, v117, v5
    v_cvt_pk_bf16_f32 v202, v116, v117
    v_mul_f32 v118, v118, v5
    v_mul_f32 v119, v119, v5
    v_cvt_pk_bf16_f32 v203, v118, v119
    s_waitcnt lgkmcnt(8)
    v_mfma_f32_32x32x16_bf16 v[32:47], v[240:243], v[196:199], v[32:47]
    ds_read_b64_tr_b16 v[240:241], v8 offset:24576
    ds_read_b64_tr_b16 v[242:243], v8 offset:26624
    v_mul_f32 v120, v120, v5
    v_mul_f32 v121, v121, v5
    v_cvt_pk_bf16_f32 v204, v120, v121
    v_mul_f32 v122, v122, v5
    v_mul_f32 v123, v123, v5
    v_cvt_pk_bf16_f32 v205, v122, v123
    v_mfma_f32_32x32x16_bf16 v[48:63], v[244:247], v[196:199], v[48:63]
    ds_read_b64_tr_b16 v[244:245], v8 offset:28672
    ds_read_b64_tr_b16 v[246:247], v8 offset:30720
    v_mul_f32 v124, v124, v5
    v_mul_f32 v125, v125, v5
    v_cvt_pk_bf16_f32 v206, v124, v125
    v_mul_f32 v126, v126, v5
    v_mul_f32 v127, v127, v5
    v_cvt_pk_bf16_f32 v207, v126, v127
    v_mfma_f32_32x32x16_bf16 v[64:79], v[248:251], v[196:199], v[64:79]
    ds_read_b64_tr_b16 v[248:249], v9 offset:8192
    ds_read_b64_tr_b16 v[250:251], v9 offset:10240
    v_mul_f32 v128, v128, v6
    v_mul_f32 v129, v129, v6
    v_cvt_pk_bf16_f32 v208, v128, v129
    v_mul_f32 v130, v130, v6
    v_mul_f32 v131, v131, v6
    v_cvt_pk_bf16_f32 v209, v130, v131
    v_mfma_f32_32x32x16_bf16 v[80:95], v[252:255], v[196:199], v[80:95]
    ds_read_b64_tr_b16 v[252:253], v9 offset:12288
    ds_read_b64_tr_b16 v[254:255], v9 offset:14336
    v_mul_f32 v132, v132, v6
    v_mul_f32 v133, v133, v6
    v_cvt_pk_bf16_f32 v210, v132, v133
    v_mul_f32 v134, v134, v6
    v_mul_f32 v135, v135, v6
    v_cvt_pk_bf16_f32 v211, v134, v135
    s_waitcnt lgkmcnt(8)
    v_mfma_f32_32x32x16_bf16 v[32:47], v[224:227], v[200:203], v[32:47]
    ds_read_b64_tr_b16 v[224:225], v9 offset:16384
    ds_read_b64_tr_b16 v[226:227], v9 offset:18432
    v_mul_f32 v136, v136, v6
    v_mul_f32 v137, v137, v6
    v_cvt_pk_bf16_f32 v212, v136, v137
    v_mul_f32 v138, v138, v6
    v_mul_f32 v139, v139, v6
    v_cvt_pk_bf16_f32 v213, v138, v139
    v_mfma_f32_32x32x16_bf16 v[32:47], v[228:231], v[204:207], v[32:47]
    ds_read_b64_tr_b16 v[228:229], v9 offset:20480
    ds_read_b64_tr_b16 v[230:231], v9 offset:22528
    v_mul_f32 v140, v140, v6
    v_mul_f32 v141, v141, v6
    v_cvt_pk_bf16_f32 v214, v140, v141
    v_mul_f32 v142, v142, v6
    v_mul_f32 v143, v143, v6
    v_cvt_pk_bf16_f32 v215, v142, v143
    v_mfma_f32_32x32x16_bf16 v[32:47], v[232:235], v[208:211], v[32:47]
    ds_read_b64_tr_b16 v[232:233], v9 offset:24576
    ds_read_b64_tr_b16 v[234:235], v9 offset:26624
    v_mul_f32 v144, v144, v7
    v_mul_f32 v145, v145, v7
    v_cvt_pk_bf16_f32 v216, v144, v145
    v_mul_f32 v146, v146, v7
    v_mul_f32 v147, v147, v7
    v_cvt_pk_bf16_f32 v217, v146, v147
    v_mfma_f32_32x32x16_bf16 v[32:47], v[236:239], v[212:215], v[32:47]
    ds_read_b64_tr_b16 v[236:237], v9 offset:28672
    ds_read_b64_tr_b16 v[238:239], v9 offset:30720
    v_mul_f32 v148, v148, v7
    v_mul_f32 v149, v149, v7
    v_cvt_pk_bf16_f32 v218, v148, v149
    v_mul_f32 v150, v150, v7
    v_mul_f32 v151, v151, v7
    v_cvt_pk_bf16_f32 v219, v150, v151
    s_waitcnt lgkmcnt(8)
    s_nop 0
    v_mfma_f32_32x32x16_bf16 v[32:47], v[240:243], v[216:219], v[32:47]
    ds_read_b64_tr_b16 v[240:241], v10 offset:8192
    ds_read_b64_tr_b16 v[242:243], v10 offset:10240
    v_mul_f32 v152, v152, v7
    v_mul_f32 v153, v153, v7
    v_cvt_pk_bf16_f32 v220, v152, v153
    v_mul_f32 v154, v154, v7
    v_mul_f32 v155, v155, v7
    v_cvt_pk_bf16_f32 v221, v154, v155
    v_mul_f32 v156, v156, v7
    v_mul_f32 v157, v157, v7
    v_cvt_pk_bf16_f32 v222, v156, v157
    v_mul_f32 v158, v158, v7
    v_mul_f32 v159, v159, v7
    v_cvt_pk_bf16_f32 v223, v158, v159
    s_nop 1
    v_mfma_f32_32x32x16_bf16 v[32:47], v[244:247], v[220:223], v[32:47]
    ds_read_b64_tr_b16 v[244:245], v10 offset:12288
    ds_read_b64_tr_b16 v[246:247], v10 offset:14336
    v_mfma_f32_32x32x16_bf16 v[48:63], v[248:251], v[200:203], v[48:63]
    ds_read_b64_tr_b16 v[248:249], v10 offset:16384
    ds_read_b64_tr_b16 v[250:251], v10 offset:18432
    v_mfma_f32_32x32x16_bf16 v[48:63], v[252:255], v[204:207], v[48:63]
    ds_read_b64_tr_b16 v[252:253], v10 offset:20480
    ds_read_b64_tr_b16 v[254:255], v10 offset:22528
    s_nop 3
    v_cvt_pk_bf16_f32 v160, v32, v33
    v_cvt_pk_bf16_f32 v161, v34, v35
    v_cvt_pk_bf16_f32 v162, v36, v37
    v_cvt_pk_bf16_f32 v163, v38, v39
    v_cvt_pk_bf16_f32 v164, v40, v41
    s_waitcnt lgkmcnt(8)
    v_mfma_f32_32x32x16_bf16 v[48:63], v[224:227], v[208:211], v[48:63]
    ds_read_b64_tr_b16 v[224:225], v10 offset:24576
    ds_read_b64_tr_b16 v[226:227], v10 offset:26624
    v_cvt_pk_bf16_f32 v165, v42, v43
    v_cvt_pk_bf16_f32 v166, v44, v45
    v_cvt_pk_bf16_f32 v167, v46, v47
    v_permlane16_swap_b32 v160, v164
    v_permlane16_swap_b32 v161, v165
    v_mfma_f32_32x32x16_bf16 v[48:63], v[228:231], v[212:215], v[48:63]
    ds_read_b64_tr_b16 v[228:229], v10 offset:28672
    ds_read_b64_tr_b16 v[230:231], v10 offset:30720
    v_permlane16_swap_b32 v162, v166
    v_permlane16_swap_b32 v163, v167
    buffer_store_dwordx4 v[160:163], v24, s[28:31], s60 offen offset:0 sc1
    buffer_store_dwordx4 v[164:167], v24, s[28:31], s60 offen offset:1024 sc1
    v_mfma_f32_32x32x16_bf16 v[48:63], v[232:235], v[216:219], v[48:63]
    ds_read_b64_tr_b16 v[232:233], v11 offset:8192
    ds_read_b64_tr_b16 v[234:235], v11 offset:10240
    v_mfma_f32_32x32x16_bf16 v[48:63], v[236:239], v[220:223], v[48:63]
    ds_read_b64_tr_b16 v[236:237], v11 offset:12288
    ds_read_b64_tr_b16 v[238:239], v11 offset:14336
    s_waitcnt lgkmcnt(8)
    v_mfma_f32_32x32x16_bf16 v[64:79], v[240:243], v[200:203], v[64:79]
    ds_read_b64_tr_b16 v[240:241], v11 offset:16384
    ds_read_b64_tr_b16 v[242:243], v11 offset:18432
    v_mfma_f32_32x32x16_bf16 v[64:79], v[244:247], v[204:207], v[64:79]
    ds_read_b64_tr_b16 v[244:245], v11 offset:20480
    ds_read_b64_tr_b16 v[246:247], v11 offset:22528
    s_nop 2
    v_cvt_pk_bf16_f32 v168, v48, v49
    v_cvt_pk_bf16_f32 v169, v50, v51
    v_cvt_pk_bf16_f32 v170, v52, v53
    v_cvt_pk_bf16_f32 v171, v54, v55
    v_cvt_pk_bf16_f32 v172, v56, v57
    v_mfma_f32_32x32x16_bf16 v[64:79], v[248:251], v[208:211], v[64:79]
    ds_read_b64_tr_b16 v[248:249], v11 offset:24576
    ds_read_b64_tr_b16 v[250:251], v11 offset:26624
    v_cvt_pk_bf16_f32 v173, v58, v59
    v_cvt_pk_bf16_f32 v174, v60, v61
    v_cvt_pk_bf16_f32 v175, v62, v63
    v_permlane16_swap_b32 v168, v172
    v_permlane16_swap_b32 v169, v173
    v_mfma_f32_32x32x16_bf16 v[64:79], v[252:255], v[212:215], v[64:79]
    ds_read_b64_tr_b16 v[252:253], v11 offset:28672
    ds_read_b64_tr_b16 v[254:255], v11 offset:30720
    v_permlane16_swap_b32 v170, v174
    v_permlane16_swap_b32 v171, v175
    buffer_store_dwordx4 v[168:171], v24, s[28:31], s60 offen offset:2048 sc1
    buffer_store_dwordx4 v[172:175], v24, s[28:31], s60 offen offset:3072 sc1
    s_waitcnt lgkmcnt(8)
    v_mfma_f32_32x32x16_bf16 v[64:79], v[224:227], v[216:219], v[64:79]
    v_mfma_f32_32x32x16_bf16 v[64:79], v[228:231], v[220:223], v[64:79]
    s_waitcnt lgkmcnt(0)
    s_barrier
    v_mfma_f32_32x32x16_bf16 v[80:95], v[232:235], v[200:203], v[80:95]
    ds_read_b64_tr_b16 v[224:225], v12 offset:32768
    ds_read_b64_tr_b16 v[226:227], v12 offset:34816
    v_mfma_f32_32x32x16_bf16 v[80:95], v[236:239], v[204:207], v[80:95]
    ds_read_b64_tr_b16 v[228:229], v13 offset:32768
    ds_read_b64_tr_b16 v[230:231], v13 offset:34816
    s_nop 3
    v_cvt_pk_bf16_f32 v176, v64, v65
    v_cvt_pk_bf16_f32 v177, v66, v67
    v_cvt_pk_bf16_f32 v178, v68, v69
    v_cvt_pk_bf16_f32 v179, v70, v71
    v_cvt_pk_bf16_f32 v180, v72, v73
    v_mfma_f32_32x32x16_bf16 v[80:95], v[240:243], v[208:211], v[80:95]
    ds_read_b64_tr_b16 v[232:233], v14 offset:32768
    ds_read_b64_tr_b16 v[234:235], v14 offset:34816
    v_cvt_pk_bf16_f32 v181, v74, v75
    v_cvt_pk_bf16_f32 v182, v76, v77
    v_cvt_pk_bf16_f32 v183, v78, v79
    v_permlane16_swap_b32 v176, v180
    v_permlane16_swap_b32 v177, v181
    v_mfma_f32_32x32x16_bf16 v[80:95], v[244:247], v[212:215], v[80:95]
    ds_read_b64_tr_b16 v[236:237], v15 offset:32768
    ds_read_b64_tr_b16 v[238:239], v15 offset:34816
    v_permlane16_swap_b32 v178, v182
    v_permlane16_swap_b32 v179, v183
    buffer_store_dwordx4 v[176:179], v24, s[28:31], s26 offen offset:0 sc1
    buffer_store_dwordx4 v[180:183], v24, s[28:31], s26 offen offset:1024 sc1
    v_mfma_f32_32x32x16_bf16 v[80:95], v[248:251], v[216:219], v[80:95]
    ds_read_b64_tr_b16 v[240:241], v16 offset:32768
    ds_read_b64_tr_b16 v[242:243], v16 offset:34816
    v_mfma_f32_32x32x16_bf16 v[80:95], v[252:255], v[220:223], v[80:95]
    ds_read_b64_tr_b16 v[244:245], v17 offset:32768
    ds_read_b64_tr_b16 v[246:247], v17 offset:34816
L_late:
    ds_read_b64_tr_b16 v[248:249], v18 offset:32768
    ds_read_b64_tr_b16 v[250:251], v18 offset:34816
    ds_read_b64_tr_b16 v[252:253], v19 offset:32768
    ds_read_b64_tr_b16 v[254:255], v19 offset:34816
    s_waitcnt lgkmcnt(8)
    v_mfma_f32_16x16x32_bf16 v[96:99], v[224:227], v[160:163], 0
    v_mfma_f32_16x16x32_bf16 v[104:107], v[224:227], v[164:167], 0
    s_nop 2
    v_cvt_pk_bf16_f32 v184, v80, v81
    v_cvt_pk_bf16_f32 v185, v82, v83
    v_cvt_pk_bf16_f32 v186, v84, v85
    v_cvt_pk_bf16_f32 v187, v86, v87
    v_cvt_pk_bf16_f32 v188, v88, v89
    v_cvt_pk_bf16_f32 v189, v90, v91
    v_cvt_pk_bf16_f32 v190, v92, v93
    v_cvt_pk_bf16_f32 v191, v94, v95
    v_permlane16_swap_b32 v184, v188
    v_permlane16_swap_b32 v185, v189
    v_permlane16_swap_b32 v186, v190
    v_permlane16_swap_b32 v187, v191
    buffer_store_dwordx4 v[184:187], v24, s[28:31], s26 offen offset:2048 sc1
    buffer_store_dwordx4 v[188:191], v24, s[28:31], s26 offen offset:3072 sc1
    ds_read_b64_tr_b16 v[224:225], v12 offset:40960
    v_mfma_f32_16x16x32_bf16 v[100:103], v[228:231], v[160:163], 0
    ds_read_b64_tr_b16 v[226:227], v12 offset:43008
    v_mfma_f32_16x16x32_bf16 v[108:111], v[228:231], v[164:167], 0
    ds_read_b64_tr_b16 v[228:229], v13 offset:40960
    v_mfma_f32_16x16x32_bf16 v[112:115], v[232:235], v[160:163], 0
    ds_read_b64_tr_b16 v[230:231], v13 offset:43008
    v_mfma_f32_16x16x32_bf16 v[120:123], v[232:235], v[164:167], 0
    ds_read_b64_tr_b16 v[232:233], v14 offset:40960
    v_mfma_f32_16x16x32_bf16 v[116:119], v[236:239], v[160:163], 0
    ds_read_b64_tr_b16 v[234:235], v14 offset:43008
    v_mfma_f32_16x16x32_bf16 v[124:127], v[236:239], v[164:167], 0
    ds_read_b64_tr_b16 v[236:237], v15 offset:40960
    s_waitcnt lgkmcnt(7)
    v_mfma_f32_16x16x32_bf16 v[128:131], v[240:243], v[160:163], 0
    ds_read_b64_tr_b16 v[238:239], v15 offset:43008
    v_mfma_f32_16x16x32_bf16 v[136:139], v[240:243], v[164:167], 0
    ds_read_b64_tr_b16 v[240:241], v16 offset:40960
    v_mfma_f32_16x16x32_bf16 v[132:135], v[244:247], v[160:163], 0
    ds_read_b64_tr_b16 v[242:243], v16 offset:43008
    v_mfma_f32_16x16x32_bf16 v[140:143], v[244:247], v[164:167], 0
    ds_read_b64_tr_b16 v[244:245], v17 offset:40960
    v_mfma_f32_16x16x32_bf16 v[144:147], v[248:251], v[160:163], 0
    ds_read_b64_tr_b16 v[246:247], v17 offset:43008
    v_mfma_f32_16x16x32_bf16 v[152:155], v[248:251], v[164:167], 0
    s_waitcnt vmcnt(8)
    v_cmp_eq_u32 vcc, 0, v21
    s_nop 0
    s_cbranch_vccnz L_ini
L_ini_ok:
    ds_read_b64_tr_b16 v[248:249], v18 offset:40960
    v_mfma_f32_16x16x32_bf16 v[148:151], v[252:255], v[160:163], 0
    ds_read_b64_tr_b16 v[250:251], v18 offset:43008
    v_mfma_f32_16x16x32_bf16 v[156:159], v[252:255], v[164:167], 0
    ds_read_b64_tr_b16 v[252:253], v19 offset:40960
    s_waitcnt lgkmcnt(7)
    v_mfma_f32_16x16x32_bf16 v[96:99], v[224:227], v[168:171], v[96:99]
    ds_read_b64_tr_b16 v[254:255], v19 offset:43008
    v_mfma_f32_16x16x32_bf16 v[104:107], v[224:227], v[172:175], v[104:107]
    ds_read_b64_tr_b16 v[224:225], v12 offset:49152
    v_mfma_f32_16x16x32_bf16 v[100:103], v[228:231], v[168:171], v[100:103]
    ds_read_b64_tr_b16 v[226:227], v12 offset:51200
    v_mfma_f32_16x16x32_bf16 v[108:111], v[228:231], v[172:175], v[108:111]
    ds_read_b64_tr_b16 v[228:229], v13 offset:49152
    v_mfma_f32_16x16x32_bf16 v[112:115], v[232:235], v[168:171], v[112:115]
    ds_read_b64_tr_b16 v[230:231], v13 offset:51200
    v_mfma_f32_16x16x32_bf16 v[120:123], v[232:235], v[172:175], v[120:123]
    ds_read_b64_tr_b16 v[232:233], v14 offset:49152
    s_waitcnt vmcnt(4)
    s_mov_b64 exec, 15
    global_atomic_or v25, v30, s[18:19] sc1
    s_mov_b64 exec, -1
    v_mfma_f32_16x16x32_bf16 v[116:119], v[236:239], v[168:171], v[116:119]
    ds_read_b64_tr_b16 v[234:235], v14 offset:51200
    v_mfma_f32_16x16x32_bf16 v[124:127], v[236:239], v[172:175], v[124:127]
    ds_read_b64_tr_b16 v[236:237], v15 offset:49152
    s_waitcnt lgkmcnt(7)
    v_mfma_f32_16x16x32_bf16 v[128:131], v[240:243], v[168:171], v[128:131]
    ds_read_b64_tr_b16 v[238:239], v15 offset:51200
    v_mfma_f32_16x16x32_bf16 v[136:139], v[240:243], v[172:175], v[136:139]
    v_add_u32 v160, 65536, v12
    v_add_u32 v161, 65536, v13
    v_add_u32 v162, 65536, v14
    v_add_u32 v163, 65536, v15
    v_add_u32 v164, 65536, v16
    v_add_u32 v165, 65536, v17
    v_add_u32 v166, 65536, v18
    v_add_u32 v167, 65536, v19
    ds_read_b64_tr_b16 v[240:241], v16 offset:49152
    v_mfma_f32_16x16x32_bf16 v[132:135], v[244:247], v[168:171], v[132:135]
    ds_read_b64_tr_b16 v[242:243], v16 offset:51200
    v_mfma_f32_16x16x32_bf16 v[140:143], v[244:247], v[172:175], v[140:143]
    ds_read_b64_tr_b16 v[244:245], v17 offset:49152
    v_mfma_f32_16x16x32_bf16 v[144:147], v[248:251], v[168:171], v[144:147]
    ds_read_b64_tr_b16 v[246:247], v17 offset:51200
    v_mfma_f32_16x16x32_bf16 v[152:155], v[248:251], v[172:175], v[152:155]
    ds_read_b64_tr_b16 v[248:249], v18 offset:49152
    v_mfma_f32_16x16x32_bf16 v[148:151], v[252:255], v[168:171], v[148:151]
    ds_read_b64_tr_b16 v[250:251], v18 offset:51200
    v_mfma_f32_16x16x32_bf16 v[156:159], v[252:255], v[172:175], v[156:159]
    ds_read_b64_tr_b16 v[252:253], v19 offset:49152
    s_waitcnt lgkmcnt(7)
    v_mfma_f32_16x16x32_bf16 v[96:99], v[224:227], v[176:179], v[96:99]
    ds_read_b64_tr_b16 v[254:255], v19 offset:51200
    v_mfma_f32_16x16x32_bf16 v[104:107], v[224:227], v[180:183], v[104:107]
    ds_read_b64_tr_b16 v[224:225], v12 offset:57344
    v_mfma_f32_16x16x32_bf16 v[100:103], v[228:231], v[176:179], v[100:103]
    ds_read_b64_tr_b16 v[226:227], v12 offset:59392
    v_mfma_f32_16x16x32_bf16 v[108:111], v[228:231], v[180:183], v[108:111]
    ds_read_b64_tr_b16 v[228:229], v13 offset:57344
    v_mfma_f32_16x16x32_bf16 v[112:115], v[232:235], v[176:179], v[112:115]
    ds_read_b64_tr_b16 v[230:231], v13 offset:59392
    v_mfma_f32_16x16x32_bf16 v[120:123], v[232:235], v[180:183], v[120:123]
    ds_read_b64_tr_b16 v[232:233], v14 offset:57344
    v_mfma_f32_16x16x32_bf16 v[116:119], v[236:239], v[176:179], v[116:119]
    ds_read_b64_tr_b16 v[234:235], v14 offset:59392
    v_mfma_f32_16x16x32_bf16 v[124:127], v[236:239], v[180:183], v[124:127]
    ds_read_b64_tr_b16 v[236:237], v15 offset:57344
    s_waitcnt lgkmcnt(7)
    v_mfma_f32_16x16x32_bf16 v[128:131], v[240:243], v[176:179], v[128:131]
    ds_read_b64_tr_b16 v[238:239], v15 offset:59392
    v_mfma_f32_16x16x32_bf16 v[136:139], v[240:243], v[180:183], v[136:139]
    ds_read_b64_tr_b16 v[240:241], v16 offset:57344
    s_waitcnt vmcnt(1)
    s_mov_b64 exec, 15
    global_atomic_or v25, v30, s[18:19] offset:16 sc1
    s_mov_b64 exec, -1
    v_mfma_f32_16x16x32_bf16 v[132:135], v[244:247], v[176:179], v[132:135]
    ds_read_b64_tr_b16 v[242:243], v16 offset:59392
    v_mfma_f32_16x16x32_bf16 v[140:143], v[244:247], v[180:183], v[140:143]
    ds_read_b64_tr_b16 v[244:245], v17 offset:57344
    v_mfma_f32_16x16x32_bf16 v[144:147], v[248:251], v[176:179], v[144:147]
    ds_read_b64_tr_b16 v[246:247], v17 offset:59392
    v_mfma_f32_16x16x32_bf16 v[152:155], v[248:251], v[180:183], v[152:155]
    ds_read_b64_tr_b16 v[248:249], v18 offset:57344
    v_mfma_f32_16x16x32_bf16 v[148:151], v[252:255], v[176:179], v[148:151]
    ds_read_b64_tr_b16 v[250:251], v18 offset:59392
    v_mfma_f32_16x16x32_bf16 v[156:159], v[252:255], v[180:183], v[156:159]
    s_waitcnt lgkmcnt(0)
    s_barrier
    ds_read_b64_tr_b16 v[252:253], v19 offset:57344
    v_mfma_f32_16x16x32_bf16 v[96:99], v[224:227], v[184:187], v[96:99]
    ds_read_b64_tr_b16 v[254:255], v19 offset:59392
    v_mfma_f32_16x16x32_bf16 v[104:107], v[224:227], v[188:191], v[104:107]
    ds_read_b64_tr_b16 v[224:225], v12 offset:0
    v_mov_b32 v23, 1
    s_mov_b64 exec, 14
    v_mov_b32 v23, 0
    buffer_atomic_or v23, v27, s[28:31], s64 offen offset:128 sc0 sc1
    s_mov_b64 exec, -1
    v_mfma_f32_16x16x32_bf16 v[100:103], v[228:231], v[184:187], v[100:103]
    ds_read_b64_tr_b16 v[226:227], v12 offset:2048
    v_mfma_f32_16x16x32_bf16 v[108:111], v[228:231], v[188:191], v[108:111]
    ds_read_b64_tr_b16 v[228:229], v12 offset:8192
    v_mfma_f32_16x16x32_bf16 v[112:115], v[232:235], v[184:187], v[112:115]
    ds_read_b64_tr_b16 v[230:231], v12 offset:10240
    v_mfma_f32_16x16x32_bf16 v[120:123], v[232:235], v[188:191], v[120:123]
    ds_read_b64_tr_b16 v[232:233], v13 offset:0
    v_mfma_f32_16x16x32_bf16 v[116:119], v[236:239], v[184:187], v[116:119]
    ds_read_b64_tr_b16 v[234:235], v13 offset:2048
    v_mfma_f32_16x16x32_bf16 v[124:127], v[236:239], v[188:191], v[124:127]
    ds_read_b64_tr_b16 v[236:237], v13 offset:8192
    v_mfma_f32_16x16x32_bf16 v[128:131], v[240:243], v[184:187], v[128:131]
    ds_read_b64_tr_b16 v[238:239], v13 offset:10240
    v_mfma_f32_16x16x32_bf16 v[136:139], v[240:243], v[188:191], v[136:139]
    ds_read_b64_tr_b16 v[240:241], v14 offset:0
    v_mfma_f32_16x16x32_bf16 v[132:135], v[244:247], v[184:187], v[132:135]
    ds_read_b64_tr_b16 v[242:243], v14 offset:2048
    v_mfma_f32_16x16x32_bf16 v[140:143], v[244:247], v[188:191], v[140:143]
    ds_read_b64_tr_b16 v[244:245], v14 offset:8192
    v_mfma_f32_16x16x32_bf16 v[144:147], v[248:251], v[184:187], v[144:147]
    ds_read_b64_tr_b16 v[246:247], v14 offset:10240
    v_mfma_f32_16x16x32_bf16 v[152:155], v[248:251], v[188:191], v[152:155]
    ds_read_b64_tr_b16 v[248:249], v15 offset:0
    s_waitcnt lgkmcnt(7)
    v_mfma_f32_16x16x32_bf16 v[148:151], v[252:255], v[184:187], v[148:151]
    ds_read_b64_tr_b16 v[250:251], v15 offset:2048
    v_mfma_f32_16x16x32_bf16 v[156:159], v[252:255], v[188:191], v[156:159]
    ds_read_b64_tr_b16 v[252:253], v15 offset:8192
    s_waitcnt vmcnt(0)
    v_cmp_ne_u32 vcc, 1, v23
    s_nop 0
    s_cbranch_vccz L_poll1_x
    s_mov_b64 exec, 14
    s_mov_b32 s50, 0
    v_mov_b32 v20, 0
    buffer_atomic_or v20, v27, s[28:31], s64 offen offset:128 sc0 sc1
L_poll1:
    v_mov_b32 v21, 0
    buffer_atomic_or v21, v27, s[28:31], s64 offen offset:128 sc0 sc1
    s_waitcnt vmcnt(1)
    v_cmp_ne_u32 vcc, 1, v20
    s_nop 1
    s_cbranch_vccz L_poll1_x
    v_mov_b32 v20, 0
    buffer_atomic_or v20, v27, s[28:31], s64 offen offset:128 sc0 sc1
    s_waitcnt vmcnt(1)
    v_cmp_ne_u32 vcc, 1, v21
    s_nop 1
    s_cbranch_vccz L_poll1_x
    s_add_u32 s50, s50, 1
    s_cmp_lt_u32 s50, 0x20000
    s_cbranch_scc1 L_poll1
L_poll1_x:
    s_mov_b64 exec, -1
    v_mov_b32 v22, 1
    s_mov_b64 exec, 14
    v_mov_b32 v22, 0
    buffer_atomic_or v22, v27, s[28:31], s64 offen offset:144 sc0 sc1
    s_mov_b64 exec, -1
    buffer_load_dwordx4 v[32:35], v24, s[28:31], s61 offen offset:0 sc1
    buffer_load_dwordx4 v[36:39], v24, s[28:31], s61 offen offset:1024 sc1
    buffer_load_dwordx4 v[40:43], v24, s[28:31], s61 offen offset:2048 sc1
    buffer_load_dwordx4 v[44:47], v24, s[28:31], s61 offen offset:3072 sc1
    buffer_load_dwordx4 v[64:67], v24, s[28:31], s62 offen offset:0 sc1
    buffer_load_dwordx4 v[68:71], v24, s[28:31], s62 offen offset:1024 sc1
    buffer_load_dwordx4 v[72:75], v24, s[28:31], s62 offen offset:2048 sc1
    buffer_load_dwordx4 v[76:79], v24, s[28:31], s62 offen offset:3072 sc1
    buffer_load_dwordx4 v[192:195], v24, s[28:31], s63 offen offset:0 sc1
    buffer_load_dwordx4 v[196:199], v24, s[28:31], s63 offen offset:1024 sc1
    buffer_load_dwordx4 v[200:203], v24, s[28:31], s63 offen offset:2048 sc1
    buffer_load_dwordx4 v[204:207], v24, s[28:31], s63 offen offset:3072 sc1
    s_waitcnt vmcnt(11)
    v_mfma_f32_16x16x32_bf16 v[96:99], v[224:227], v[32:35], v[96:99]
    ds_read_b64_tr_b16 v[254:255], v15 offset:10240
    s_waitcnt vmcnt(10)
    v_mfma_f32_16x16x32_bf16 v[104:107], v[224:227], v[36:39], v[104:107]
    v_cmp_ne_u32 vcc, 1, v22
    s_nop 0
    s_cbranch_vccnz L_pb
L_pb_ok:
    s_add_u32 s61, s61, 4096
    buffer_load_dwordx4 v[48:51], v24, s[28:31], s61 offen offset:0 sc1
    buffer_load_dwordx4 v[52:55], v24, s[28:31], s61 offen offset:1024 sc1
    buffer_load_dwordx4 v[56:59], v24, s[28:31], s61 offen offset:2048 sc1
    buffer_load_dwordx4 v[60:63], v24, s[28:31], s61 offen offset:3072 sc1
    s_add_u32 s62, s62, 4096
    buffer_load_dwordx4 v[80:83], v24, s[28:31], s62 offen offset:0 sc1
    buffer_load_dwordx4 v[84:87], v24, s[28:31], s62 offen offset:1024 sc1
    buffer_load_dwordx4 v[88:91], v24, s[28:31], s62 offen offset:2048 sc1
    buffer_load_dwordx4 v[92:95], v24, s[28:31], s62 offen offset:3072 sc1
    s_add_u32 s63, s63, 4096
    buffer_load_dwordx4 v[208:211], v24, s[28:31], s63 offen offset:0 sc1
    buffer_load_dwordx4 v[212:215], v24, s[28:31], s63 offen offset:1024 sc1
    buffer_load_dwordx4 v[216:219], v24, s[28:31], s63 offen offset:2048 sc1
    buffer_load_dwordx4 v[220:223], v24, s[28:31], s63 offen offset:3072 sc1
    ds_read_b64_tr_b16 v[224:225], v12 offset:16384
    s_waitcnt vmcnt(21)
    v_mfma_f32_16x16x32_bf16 v[96:99], v[228:231], v[40:43], v[96:99]
    ds_read_b64_tr_b16 v[226:227], v12 offset:18432
    s_waitcnt vmcnt(20)
    v_mfma_f32_16x16x32_bf16 v[104:107], v[228:231], v[44:47], v[104:107]
    ds_read_b64_tr_b16 v[228:229], v12 offset:24576
    v_mfma_f32_16x16x32_bf16 v[100:103], v[232:235], v[32:35], v[100:103]
    ds_read_b64_tr_b16 v[230:231], v12 offset:26624
    v_mfma_f32_16x16x32_bf16 v[108:111], v[232:235], v[36:39], v[108:111]
    ds_read_b64_tr_b16 v[232:233], v13 offset:16384
    s_waitcnt lgkmcnt(7)
    v_mfma_f32_16x16x32_bf16 v[100:103], v[236:239], v[40:43], v[100:103]
    ds_read_b64_tr_b16 v[234:235], v13 offset:18432
    v_mfma_f32_16x16x32_bf16 v[108:111], v[236:239], v[44:47], v[108:111]
    ds_read_b64_tr_b16 v[236:237], v13 offset:24576
    v_mfma_f32_16x16x32_bf16 v[112:115], v[240:243], v[32:35], v[112:115]
    ds_read_b64_tr_b16 v[238:239], v13 offset:26624
    v_mfma_f32_16x16x32_bf16 v[120:123], v[240:243], v[36:39], v[120:123]
    ds_read_b64_tr_b16 v[240:241], v14 offset:16384
    v_mfma_f32_16x16x32_bf16 v[112:115], v[244:247], v[40:43], v[112:115]
    ds_read_b64_tr_b16 v[242:243], v14 offset:18432
    v_mfma_f32_16x16x32_bf16 v[120:123], v[244:247], v[44:47], v[120:123]
    ds_read_b64_tr_b16 v[244:245], v14 offset:24576
    v_mfma_f32_16x16x32_bf16 v[116:119], v[248:251], v[32:35], v[116:119]
    ds_read_b64_tr_b16 v[246:247], v14 offset:26624
    v_mfma_f32_16x16x32_bf16 v[124:127], v[248:251], v[36:39], v[124:127]
    ds_read_b64_tr_b16 v[248:249], v15 offset:16384
    s_waitcnt lgkmcnt(7)
    v_mfma_f32_16x16x32_bf16 v[116:119], v[252:255], v[40:43], v[116:119]
    ds_read_b64_tr_b16 v[250:251], v15 offset:18432
    v_mfma_f32_16x16x32_bf16 v[124:127], v[252:255], v[44:47], v[124:127]
    ds_read_b64_tr_b16 v[252:253], v15 offset:24576
    s_waitcnt vmcnt(19)
    v_mfma_f32_16x16x32_bf16 v[96:99], v[224:227], v[64:67], v[96:99]
    ds_read_b64_tr_b16 v[254:255], v15 offset:26624
    s_waitcnt vmcnt(18)
    v_mfma_f32_16x16x32_bf16 v[104:107], v[224:227], v[68:71], v[104:107]
    ds_read_b64_tr_b16 v[224:225], v160 offset:32768
    s_waitcnt vmcnt(17)
    v_mfma_f32_16x16x32_bf16 v[96:99], v[228:231], v[72:75], v[96:99]
    ds_read_b64_tr_b16 v[226:227], v160 offset:34816
    s_waitcnt vmcnt(16)
    v_mfma_f32_16x16x32_bf16 v[104:107], v[228:231], v[76:79], v[104:107]
    ds_read_b64_tr_b16 v[228:229], v160 offset:40960
    v_mfma_f32_16x16x32_bf16 v[100:103], v[232:235], v[64:67], v[100:103]
    ds_read_b64_tr_b16 v[230:231], v160 offset:43008
    v_mfma_f32_16x16x32_bf16 v[108:111], v[232:235], v[68:71], v[108:111]
    ds_read_b64_tr_b16 v[232:233], v161 offset:32768
    s_waitcnt lgkmcnt(7)
    v_mfma_f32_16x16x32_bf16 v[100:103], v[236:239], v[72:75], v[100:103]
    ds_read_b64_tr_b16 v[234:235], v161 offset:34816
    v_mfma_f32_16x16x32_bf16 v[108:111], v[236:239], v[76:79], v[108:111]
    ds_read_b64_tr_b16 v[236:237], v161 offset:40960
    v_mfma_f32_16x16x32_bf16 v[112:115], v[240:243], v[64:67], v[112:115]
    ds_read_b64_tr_b16 v[238:239], v161 offset:43008
    v_mfma_f32_16x16x32_bf16 v[120:123], v[240:243], v[68:71], v[120:123]
    ds_read_b64_tr_b16 v[240:241], v162 offset:32768
    v_mfma_f32_16x16x32_bf16 v[112:115], v[244:247], v[72:75], v[112:115]
    ds_read_b64_tr_b16 v[242:243], v162 offset:34816
    v_mfma_f32_16x16x32_bf16 v[120:123], v[244:247], v[76:79], v[120:123]
    ds_read_b64_tr_b16 v[244:245], v162 offset:40960
    v_mfma_f32_16x16x32_bf16 v[116:119], v[248:251], v[64:67], v[116:119]
    ds_read_b64_tr_b16 v[246:247], v162 offset:43008
    v_mfma_f32_16x16x32_bf16 v[124:127], v[248:251], v[68:71], v[124:127]
    ds_read_b64_tr_b16 v[248:249], v163 offset:32768
    s_waitcnt lgkmcnt(7)
    v_mfma_f32_16x16x32_bf16 v[116:119], v[252:255], v[72:75], v[116:119]
    ds_read_b64_tr_b16 v[250:251], v163 offset:34816
    v_mfma_f32_16x16x32_bf16 v[124:127], v[252:255], v[76:79], v[124:127]
    ds_read_b64_tr_b16 v[252:253], v163 offset:40960
    s_waitcnt vmcnt(15)
    v_mfma_f32_16x16x32_bf16 v[96:99], v[224:227], v[192:195], v[96:99]
    ds_read_b64_tr_b16 v[254:255], v163 offset:43008
    s_waitcnt vmcnt(14)
    v_mfma_f32_16x16x32_bf16 v[104:107], v[224:227], v[196:199], v[104:107]
    ds_read_b64_tr_b16 v[224:225], v160 offset:0
    s_waitcnt vmcnt(13)
    v_mfma_f32_16x16x32_bf16 v[96:99], v[228:231], v[200:203], v[96:99]
    ds_read_b64_tr_b16 v[226:227], v160 offset:2048
    s_waitcnt vmcnt(12)
    v_mfma_f32_16x16x32_bf16 v[104:107], v[228:231], v[204:207], v[104:107]
    ds_read_b64_tr_b16 v[228:229], v160 offset:8192
    v_mfma_f32_16x16x32_bf16 v[100:103], v[232:235], v[192:195], v[100:103]
    ds_read_b64_tr_b16 v[230:231], v160 offset:10240
    v_mfma_f32_16x16x32_bf16 v[108:111], v[232:235], v[196:199], v[108:111]
    ds_read_b64_tr_b16 v[232:233], v161 offset:0
    s_waitcnt lgkmcnt(7)
    v_mfma_f32_16x16x32_bf16 v[100:103], v[236:239], v[200:203], v[100:103]
    ds_read_b64_tr_b16 v[234:235], v161 offset:2048
    v_mfma_f32_16x16x32_bf16 v[108:111], v[236:239], v[204:207], v[108:111]
    ds_read_b64_tr_b16 v[236:237], v161 offset:8192
    v_mfma_f32_16x16x32_bf16 v[112:115], v[240:243], v[192:195], v[112:115]
    ds_read_b64_tr_b16 v[238:239], v161 offset:10240
    v_mfma_f32_16x16x32_bf16 v[120:123], v[240:243], v[196:199], v[120:123]
    ds_read_b64_tr_b16 v[240:241], v160 offset:16384
    v_mfma_f32_16x16x32_bf16 v[112:115], v[244:247], v[200:203], v[112:115]
    ds_read_b64_tr_b16 v[242:243], v160 offset:18432
    v_mfma_f32_16x16x32_bf16 v[120:123], v[244:247], v[204:207], v[120:123]
    ds_read_b64_tr_b16 v[244:245], v160 offset:24576
    v_mfma_f32_16x16x32_bf16 v[116:119], v[248:251], v[192:195], v[116:119]
    ds_read_b64_tr_b16 v[246:247], v160 offset:26624
    v_mfma_f32_16x16x32_bf16 v[124:127], v[248:251], v[196:199], v[124:127]
    ds_read_b64_tr_b16 v[248:249], v161 offset:16384
    s_waitcnt lgkmcnt(7)
    v_mfma_f32_16x16x32_bf16 v[116:119], v[252:255], v[200:203], v[116:119]
    ds_read_b64_tr_b16 v[250:251], v161 offset:18432
    v_mfma_f32_16x16x32_bf16 v[124:127], v[252:255], v[204:207], v[124:127]
    ds_read_b64_tr_b16 v[252:253], v161 offset:24576
    s_waitcnt vmcnt(11)
    v_mfma_f32_16x16x32_bf16 v[96:99], v[224:227], v[48:51], v[96:99]
    ds_read_b64_tr_b16 v[254:255], v161 offset:26624
    s_waitcnt vmcnt(10)
    v_mfma_f32_16x16x32_bf16 v[104:107], v[224:227], v[52:55], v[104:107]
    ds_read_b64_tr_b16 v[224:225], v160 offset:49152
    s_waitcnt vmcnt(9)
    v_mfma_f32_16x16x32_bf16 v[96:99], v[228:231], v[56:59], v[96:99]
    ds_read_b64_tr_b16 v[226:227], v160 offset:51200
    s_waitcnt vmcnt(8)
    v_mfma_f32_16x16x32_bf16 v[104:107], v[228:231], v[60:63], v[104:107]
    ds_read_b64_tr_b16 v[228:229], v160 offset:57344
    v_mfma_f32_16x16x32_bf16 v[100:103], v[232:235], v[48:51], v[100:103]
    ds_read_b64_tr_b16 v[230:231], v160 offset:59392
    v_mfma_f32_16x16x32_bf16 v[108:111], v[232:235], v[52:55], v[108:111]
    ds_read_b64_tr_b16 v[232:233], v161 offset:49152
    s_waitcnt lgkmcnt(7)
    v_mfma_f32_16x16x32_bf16 v[100:103], v[236:239], v[56:59], v[100:103]
    ds_read_b64_tr_b16 v[234:235], v161 offset:51200
    v_mfma_f32_16x16x32_bf16 v[108:111], v[236:239], v[60:63], v[108:111]
    ds_read_b64_tr_b16 v[236:237], v161 offset:57344
    s_waitcnt vmcnt(7)
    v_mfma_f32_16x16x32_bf16 v[96:99], v[240:243], v[80:83], v[96:99]
    ds_read_b64_tr_b16 v[238:239], v161 offset:59392
    s_waitcnt vmcnt(6)
    v_mfma_f32_16x16x32_bf16 v[104:107], v[240:243], v[84:87], v[104:107]
    ds_read_b64_tr_b16 v[240:241], v162 offset:0
    s_waitcnt vmcnt(5)
    v_mfma_f32_16x16x32_bf16 v[96:99], v[244:247], v[88:91], v[96:99]
    ds_read_b64_tr_b16 v[242:243], v162 offset:2048
    s_waitcnt vmcnt(4)
    v_mfma_f32_16x16x32_bf16 v[104:107], v[244:247], v[92:95], v[104:107]
    ds_read_b64_tr_b16 v[244:245], v162 offset:8192
    v_mfma_f32_16x16x32_bf16 v[100:103], v[248:251], v[80:83], v[100:103]
    ds_read_b64_tr_b16 v[246:247], v162 offset:10240
    v_mfma_f32_16x16x32_bf16 v[108:111], v[248:251], v[84:87], v[108:111]
    ds_read_b64_tr_b16 v[248:249], v163 offset:0
    s_waitcnt lgkmcnt(7)
    v_mfma_f32_16x16x32_bf16 v[100:103], v[252:255], v[88:91], v[100:103]
    ds_read_b64_tr_b16 v[250:251], v163 offset:2048
    v_mfma_f32_16x16x32_bf16 v[108:111], v[252:255], v[92:95], v[108:111]
    ds_read_b64_tr_b16 v[252:253], v163 offset:8192
    s_waitcnt vmcnt(3)
    v_mfma_f32_16x16x32_bf16 v[96:99], v[224:227], v[208:211], v[96:99]
    ds_read_b64_tr_b16 v[254:255], v163 offset:10240
    s_waitcnt vmcnt(2)
    v_mfma_f32_16x16x32_bf16 v[104:107], v[224:227], v[212:215], v[104:107]
    ds_read_b64_tr_b16 v[224:225], v162 offset:16384
    s_waitcnt vmcnt(1)
    v_mfma_f32_16x16x32_bf16 v[96:99], v[228:231], v[216:219], v[96:99]
    ds_read_b64_tr_b16 v[226:227], v162 offset:18432
    s_waitcnt vmcnt(0)
    v_mfma_f32_16x16x32_bf16 v[104:107], v[228:231], v[220:223], v[104:107]
    ds_read_b64_tr_b16 v[228:229], v162 offset:24576
    v_mfma_f32_16x16x32_bf16 v[100:103], v[232:235], v[208:211], v[100:103]
    ds_read_b64_tr_b16 v[230:231], v162 offset:26624
    v_mfma_f32_16x16x32_bf16 v[108:111], v[232:235], v[212:215], v[108:111]
    ds_read_b64_tr_b16 v[232:233], v163 offset:16384
    s_waitcnt lgkmcnt(7)
    v_mfma_f32_16x16x32_bf16 v[100:103], v[236:239], v[216:219], v[100:103]
    ds_read_b64_tr_b16 v[234:235], v163 offset:18432
    v_mfma_f32_16x16x32_bf16 v[108:111], v[236:239], v[220:223], v[108:111]
    ds_read_b64_tr_b16 v[236:237], v163 offset:24576
    v_mfma_f32_16x16x32_bf16 v[112:115], v[240:243], v[48:51], v[112:115]
    ds_read_b64_tr_b16 v[238:239], v163 offset:26624
    v_mfma_f32_16x16x32_bf16 v[120:123], v[240:243], v[52:55], v[120:123]
    ds_read_b64_tr_b16 v[240:241], v162 offset:49152
    v_mfma_f32_16x16x32_bf16 v[112:115], v[244:247], v[56:59], v[112:115]
    ds_read_b64_tr_b16 v[242:243], v162 offset:51200
    v_mfma_f32_16x16x32_bf16 v[120:123], v[244:247], v[60:63], v[120:123]
    ds_read_b64_tr_b16 v[244:245], v162 offset:57344
    v_cvt_pk_bf16_f32 v4, v96, v97
    v_cvt_pk_bf16_f32 v5, v98, v99
    v_cvt_pk_bf16_f32 v6, v100, v101
    v_mfma_f32_16x16x32_bf16 v[116:119], v[248:251], v[48:51], v[116:119]
    ds_read_b64_tr_b16 v[246:247], v162 offset:59392
    v_mfma_f32_16x16x32_bf16 v[124:127], v[248:251], v[52:55], v[124:127]
    ds_read_b64_tr_b16 v[248:249], v163 offset:49152
    v_cvt_pk_bf16_f32 v7, v102, v103
    buffer_store_dwordx4 v[4:7], v24, s[28:31], s52 offen sc1
    v_cvt_pk_bf16_f32 v8, v104, v105
    s_waitcnt lgkmcnt(7)
    v_mfma_f32_16x16x32_bf16 v[116:119], v[252:255], v[56:59], v[116:119]
    ds_read_b64_tr_b16 v[250:251], v163 offset:51200
    v_mfma_f32_16x16x32_bf16 v[124:127], v[252:255], v[60:63], v[124:127]
    ds_read_b64_tr_b16 v[252:253], v163 offset:57344
    v_cvt_pk_bf16_f32 v9, v106, v107
    v_cvt_pk_bf16_f32 v10, v108, v109
    v_cvt_pk_bf16_f32 v11, v110, v111
    v_mfma_f32_16x16x32_bf16 v[112:115], v[224:227], v[80:83], v[112:115]
    ds_read_b64_tr_b16 v[254:255], v163 offset:59392
    v_mfma_f32_16x16x32_bf16 v[120:123], v[224:227], v[84:87], v[120:123]
    ds_read_b64_tr_b16 v[224:225], v16 offset:0
    buffer_store_dwordx4 v[8:11], v24, s[28:31], s53 offen sc1
    v_mfma_f32_16x16x32_bf16 v[112:115], v[228:231], v[88:91], v[112:115]
    ds_read_b64_tr_b16 v[226:227], v16 offset:2048
    v_mfma_f32_16x16x32_bf16 v[120:123], v[228:231], v[92:95], v[120:123]
    ds_read_b64_tr_b16 v[228:229], v16 offset:8192
    v_mfma_f32_16x16x32_bf16 v[116:119], v[232:235], v[80:83], v[116:119]
    ds_read_b64_tr_b16 v[230:231], v16 offset:10240
    v_mfma_f32_16x16x32_bf16 v[124:127], v[232:235], v[84:87], v[124:127]
    ds_read_b64_tr_b16 v[232:233], v164 offset:0
    s_waitcnt lgkmcnt(7)
    v_mfma_f32_16x16x32_bf16 v[116:119], v[236:239], v[88:91], v[116:119]
    ds_read_b64_tr_b16 v[234:235], v164 offset:2048
    v_mfma_f32_16x16x32_bf16 v[124:127], v[236:239], v[92:95], v[124:127]
    ds_read_b64_tr_b16 v[236:237], v164 offset:8192
    v_mfma_f32_16x16x32_bf16 v[112:115], v[240:243], v[208:211], v[112:115]
    ds_read_b64_tr_b16 v[238:239], v164 offset:10240
    v_mfma_f32_16x16x32_bf16 v[120:123], v[240:243], v[212:215], v[120:123]
    ds_read_b64_tr_b16 v[240:241], v17 offset:0
    v_mfma_f32_16x16x32_bf16 v[112:115], v[244:247], v[216:219], v[112:115]
    ds_read_b64_tr_b16 v[242:243], v17 offset:2048
    v_mfma_f32_16x16x32_bf16 v[120:123], v[244:247], v[220:223], v[120:123]
    ds_read_b64_tr_b16 v[244:245], v17 offset:8192
    v_mfma_f32_16x16x32_bf16 v[116:119], v[248:251], v[208:211], v[116:119]
    ds_read_b64_tr_b16 v[246:247], v17 offset:10240
    v_mfma_f32_16x16x32_bf16 v[124:127], v[248:251], v[212:215], v[124:127]
    ds_read_b64_tr_b16 v[248:249], v165 offset:0
    s_waitcnt lgkmcnt(7)
    v_mfma_f32_16x16x32_bf16 v[116:119], v[252:255], v[216:219], v[116:119]
    ds_read_b64_tr_b16 v[250:251], v165 offset:2048
    v_mfma_f32_16x16x32_bf16 v[124:127], v[252:255], v[220:223], v[124:127]
    ds_read_b64_tr_b16 v[252:253], v165 offset:8192
    v_mfma_f32_16x16x32_bf16 v[128:131], v[224:227], v[32:35], v[128:131]
    ds_read_b64_tr_b16 v[254:255], v165 offset:10240
    v_mfma_f32_16x16x32_bf16 v[136:139], v[224:227], v[36:39], v[136:139]
    ds_read_b64_tr_b16 v[224:225], v16 offset:16384
    v_mfma_f32_16x16x32_bf16 v[128:131], v[228:231], v[40:43], v[128:131]
    ds_read_b64_tr_b16 v[226:227], v16 offset:18432
    v_mfma_f32_16x16x32_bf16 v[136:139], v[228:231], v[44:47], v[136:139]
    ds_read_b64_tr_b16 v[228:229], v16 offset:24576
    v_cvt_pk_bf16_f32 v4, v112, v113
    v_cvt_pk_bf16_f32 v5, v114, v115
    v_cvt_pk_bf16_f32 v6, v116, v117
    v_mfma_f32_16x16x32_bf16 v[128:131], v[232:235], v[48:51], v[128:131]
    ds_read_b64_tr_b16 v[230:231], v16 offset:26624
    v_mfma_f32_16x16x32_bf16 v[136:139], v[232:235], v[52:55], v[136:139]
    ds_read_b64_tr_b16 v[232:233], v164 offset:16384
    v_cvt_pk_bf16_f32 v7, v118, v119
    buffer_store_dwordx4 v[4:7], v24, s[28:31], s54 offen sc1
    v_cvt_pk_bf16_f32 v8, v120, v121
    s_waitcnt lgkmcnt(7)
    v_mfma_f32_16x16x32_bf16 v[128:131], v[236:239], v[56:59], v[128:131]
    ds_read_b64_tr_b16 v[234:235], v164 offset:18432
    v_mfma_f32_16x16x32_bf16 v[136:139], v[236:239], v[60:63], v[136:139]
    ds_read_b64_tr_b16 v[236:237], v164 offset:24576
    v_cvt_pk_bf16_f32 v9, v122, v123
    v_cvt_pk_bf16_f32 v10, v124, v125
    v_cvt_pk_bf16_f32 v11, v126, v127
    v_mfma_f32_16x16x32_bf16 v[132:135], v[240:243], v[32:35], v[132:135]
    ds_read_b64_tr_b16 v[238:239], v164 offset:26624
    v_mfma_f32_16x16x32_bf16 v[140:143], v[240:243], v[36:39], v[140:143]
    ds_read_b64_tr_b16 v[240:241], v17 offset:16384
    buffer_store_dwordx4 v[8:11], v24, s[28:31], s55 offen sc1
    v_mfma_f32_16x16x32_bf16 v[132:135], v[244:247], v[40:43], v[132:135]
    ds_read_b64_tr_b16 v[242:243], v17 offset:18432
    v_mfma_f32_16x16x32_bf16 v[140:143], v[244:247], v[44:47], v[140:143]
    ds_read_b64_tr_b16 v[244:245], v17 offset:24576
    v_mfma_f32_16x16x32_bf16 v[132:135], v[248:251], v[48:51], v[132:135]
    ds_read_b64_tr_b16 v[246:247], v17 offset:26624
    v_mfma_f32_16x16x32_bf16 v[140:143], v[248:251], v[52:55], v[140:143]
    ds_read_b64_tr_b16 v[248:249], v165 offset:16384
    s_waitcnt lgkmcnt(7)
    v_mfma_f32_16x16x32_bf16 v[132:135], v[252:255], v[56:59], v[132:135]
    ds_read_b64_tr_b16 v[250:251], v165 offset:18432
    v_mfma_f32_16x16x32_bf16 v[140:143], v[252:255], v[60:63], v[140:143]
    ds_read_b64_tr_b16 v[252:253], v165 offset:24576
    v_mfma_f32_16x16x32_bf16 v[128:131], v[224:227], v[64:67], v[128:131]
    ds_read_b64_tr_b16 v[254:255], v165 offset:26624
    v_mfma_f32_16x16x32_bf16 v[136:139], v[224:227], v[68:71], v[136:139]
    ds_read_b64_tr_b16 v[224:225], v164 offset:32768
    v_mfma_f32_16x16x32_bf16 v[128:131], v[228:231], v[72:75], v[128:131]
    ds_read_b64_tr_b16 v[226:227], v164 offset:34816
    v_mfma_f32_16x16x32_bf16 v[136:139], v[228:231], v[76:79], v[136:139]
    ds_read_b64_tr_b16 v[228:229], v164 offset:40960
    v_mfma_f32_16x16x32_bf16 v[128:131], v[232:235], v[80:83], v[128:131]
    ds_read_b64_tr_b16 v[230:231], v164 offset:43008
    v_mfma_f32_16x16x32_bf16 v[136:139], v[232:235], v[84:87], v[136:139]
    ds_read_b64_tr_b16 v[232:233], v164 offset:49152
    s_waitcnt lgkmcnt(7)
    v_mfma_f32_16x16x32_bf16 v[128:131], v[236:239], v[88:91], v[128:131]
    ds_read_b64_tr_b16 v[234:235], v164 offset:51200
    v_mfma_f32_16x16x32_bf16 v[136:139], v[236:239], v[92:95], v[136:139]
    ds_read_b64_tr_b16 v[236:237], v164 offset:57344
    v_mfma_f32_16x16x32_bf16 v[132:135], v[240:243], v[64:67], v[132:135]
    ds_read_b64_tr_b16 v[238:239], v164 offset:59392
    v_mfma_f32_16x16x32_bf16 v[140:143], v[240:243], v[68:71], v[140:143]
    ds_read_b64_tr_b16 v[240:241], v165 offset:32768
    v_mfma_f32_16x16x32_bf16 v[132:135], v[244:247], v[72:75], v[132:135]
    ds_read_b64_tr_b16 v[242:243], v165 offset:34816
    v_mfma_f32_16x16x32_bf16 v[140:143], v[244:247], v[76:79], v[140:143]
    ds_read_b64_tr_b16 v[244:245], v165 offset:40960
    v_mfma_f32_16x16x32_bf16 v[132:135], v[248:251], v[80:83], v[132:135]
    ds_read_b64_tr_b16 v[246:247], v165 offset:43008
    v_mfma_f32_16x16x32_bf16 v[140:143], v[248:251], v[84:87], v[140:143]
    ds_read_b64_tr_b16 v[248:249], v165 offset:49152
    s_waitcnt lgkmcnt(7)
    v_mfma_f32_16x16x32_bf16 v[132:135], v[252:255], v[88:91], v[132:135]
    ds_read_b64_tr_b16 v[250:251], v165 offset:51200
    v_mfma_f32_16x16x32_bf16 v[140:143], v[252:255], v[92:95], v[140:143]
    ds_read_b64_tr_b16 v[252:253], v165 offset:57344
    v_mfma_f32_16x16x32_bf16 v[128:131], v[224:227], v[192:195], v[128:131]
    ds_read_b64_tr_b16 v[254:255], v165 offset:59392
    v_mfma_f32_16x16x32_bf16 v[136:139], v[224:227], v[196:199], v[136:139]
    ds_read_b64_tr_b16 v[224:225], v18 offset:0
    v_mfma_f32_16x16x32_bf16 v[128:131], v[228:231], v[200:203], v[128:131]
    ds_read_b64_tr_b16 v[226:227], v18 offset:2048
    v_mfma_f32_16x16x32_bf16 v[136:139], v[228:231], v[204:207], v[136:139]
    ds_read_b64_tr_b16 v[228:229], v18 offset:8192
    v_mfma_f32_16x16x32_bf16 v[128:131], v[232:235], v[208:211], v[128:131]
    ds_read_b64_tr_b16 v[230:231], v18 offset:10240
    v_mfma_f32_16x16x32_bf16 v[136:139], v[232:235], v[212:215], v[136:139]
    ds_read_b64_tr_b16 v[232:233], v166 offset:0
    s_waitcnt lgkmcnt(7)
    v_mfma_f32_16x16x32_bf16 v[128:131], v[236:239], v[216:219], v[128:131]
    ds_read_b64_tr_b16 v[234:235], v166 offset:2048
    v_mfma_f32_16x16x32_bf16 v[136:139], v[236:239], v[220:223], v[136:139]
    ds_read_b64_tr_b16 v[236:237], v166 offset:8192
    v_mfma_f32_16x16x32_bf16 v[132:135], v[240:243], v[192:195], v[132:135]
    ds_read_b64_tr_b16 v[238:239], v166 offset:10240
    v_mfma_f32_16x16x32_bf16 v[140:143], v[240:243], v[196:199], v[140:143]
    ds_read_b64_tr_b16 v[240:241], v19 offset:0
    v_mfma_f32_16x16x32_bf16 v[132:135], v[244:247], v[200:203], v[132:135]
    ds_read_b64_tr_b16 v[242:243], v19 offset:2048
    v_mfma_f32_16x16x32_bf16 v[140:143], v[244:247], v[204:207], v[140:143]
    ds_read_b64_tr_b16 v[244:245], v19 offset:8192
    v_mfma_f32_16x16x32_bf16 v[132:135], v[248:251], v[208:211], v[132:135]
    ds_read_b64_tr_b16 v[246:247], v19 offset:10240
    v_mfma_f32_16x16x32_bf16 v[140:143], v[248:251], v[212:215], v[140:143]
    ds_read_b64_tr_b16 v[248:249], v167 offset:0
    s_waitcnt lgkmcnt(7)
    v_mfma_f32_16x16x32_bf16 v[132:135], v[252:255], v[216:219], v[132:135]
    ds_read_b64_tr_b16 v[250:251], v167 offset:2048
    v_mfma_f32_16x16x32_bf16 v[140:143], v[252:255], v[220:223], v[140:143]
    ds_read_b64_tr_b16 v[252:253], v167 offset:8192
    v_mfma_f32_16x16x32_bf16 v[144:147], v[224:227], v[32:35], v[144:147]
    ds_read_b64_tr_b16 v[254:255], v167 offset:10240
    ds_read_b64_tr_b16 v[224:225], v18 offset:16384
    v_mfma_f32_16x16x32_bf16 v[144:147], v[228:231], v[40:43], v[144:147]
    ds_read_b64_tr_b16 v[226:227], v18 offset:18432
    ds_read_b64_tr_b16 v[228:229], v18 offset:24576
    v_cvt_pk_bf16_f32 v4, v128, v129
    v_cvt_pk_bf16_f32 v5, v130, v131
    v_cvt_pk_bf16_f32 v6, v132, v133
    v_mfma_f32_16x16x32_bf16 v[144:147], v[232:235], v[48:51], v[144:147]
    ds_read_b64_tr_b16 v[230:231], v18 offset:26624
    ds_read_b64_tr_b16 v[232:233], v166 offset:16384
    v_cvt_pk_bf16_f32 v7, v134, v135
    buffer_store_dwordx4 v[4:7], v24, s[28:31], s56 offen sc1
    v_cvt_pk_bf16_f32 v8, v136, v137
    s_waitcnt lgkmcnt(7)
    v_mfma_f32_16x16x32_bf16 v[144:147], v[236:239], v[56:59], v[144:147]
    ds_read_b64_tr_b16 v[234:235], v166 offset:18432
    ds_read_b64_tr_b16 v[236:237], v166 offset:24576
    v_cvt_pk_bf16_f32 v9, v138, v139
    v_cvt_pk_bf16_f32 v10, v140, v141
    v_cvt_pk_bf16_f32 v11, v142, v143
    v_mfma_f32_16x16x32_bf16 v[148:151], v[240:243], v[32:35], v[148:151]
    ds_read_b64_tr_b16 v[238:239], v166 offset:26624
    ds_read_b64_tr_b16 v[240:241], v19 offset:16384
    buffer_store_dwordx4 v[8:11], v24, s[28:31], s57 offen sc1
    v_mfma_f32_16x16x32_bf16 v[148:151], v[244:247], v[40:43], v[148:151]
    ds_read_b64_tr_b16 v[242:243], v19 offset:18432
    ds_read_b64_tr_b16 v[244:245], v19 offset:24576
    v_mfma_f32_16x16x32_bf16 v[148:151], v[248:251], v[48:51], v[148:151]
    ds_read_b64_tr_b16 v[246:247], v19 offset:26624
    ds_read_b64_tr_b16 v[248:249], v167 offset:16384
    s_waitcnt lgkmcnt(7)
    v_mfma_f32_16x16x32_bf16 v[148:151], v[252:255], v[56:59], v[148:151]
    ds_read_b64_tr_b16 v[250:251], v167 offset:18432
    ds_read_b64_tr_b16 v[252:253], v167 offset:24576
    v_mfma_f32_16x16x32_bf16 v[144:147], v[224:227], v[64:67], v[144:147]
    ds_read_b64_tr_b16 v[254:255], v167 offset:26624
    ds_read_b64_tr_b16 v[224:225], v166 offset:32768
    v_mfma_f32_16x16x32_bf16 v[144:147], v[228:231], v[72:75], v[144:147]
    ds_read_b64_tr_b16 v[226:227], v166 offset:34816
    ds_read_b64_tr_b16 v[228:229], v166 offset:40960
    v_mfma_f32_16x16x32_bf16 v[144:147], v[232:235], v[80:83], v[144:147]
    ds_read_b64_tr_b16 v[230:231], v166 offset:43008
    ds_read_b64_tr_b16 v[232:233], v166 offset:49152
    s_waitcnt lgkmcnt(7)
    v_mfma_f32_16x16x32_bf16 v[144:147], v[236:239], v[88:91], v[144:147]
    ds_read_b64_tr_b16 v[234:235], v166 offset:51200
    ds_read_b64_tr_b16 v[236:237], v166 offset:57344
    v_mfma_f32_16x16x32_bf16 v[148:151], v[240:243], v[64:67], v[148:151]
    ds_read_b64_tr_b16 v[238:239], v166 offset:59392
    ds_read_b64_tr_b16 v[240:241], v167 offset:32768
    v_mfma_f32_16x16x32_bf16 v[148:151], v[244:247], v[72:75], v[148:151]
    ds_read_b64_tr_b16 v[242:243], v167 offset:34816
    ds_read_b64_tr_b16 v[244:245], v167 offset:40960
    v_mfma_f32_16x16x32_bf16 v[148:151], v[248:251], v[80:83], v[148:151]
    ds_read_b64_tr_b16 v[246:247], v167 offset:43008
    ds_read_b64_tr_b16 v[248:249], v167 offset:49152
    s_waitcnt vmcnt(2)
    s_mov_b64 exec, 15
    global_atomic_or v26, v30, s[18:19] sc1
    s_mov_b64 exec, -1
    s_waitcnt lgkmcnt(7)
    v_mfma_f32_16x16x32_bf16 v[148:151], v[252:255], v[88:91], v[148:151]
    ds_read_b64_tr_b16 v[250:251], v167 offset:51200
    ds_read_b64_tr_b16 v[252:253], v167 offset:57344
    v_mfma_f32_16x16x32_bf16 v[144:147], v[224:227], v[192:195], v[144:147]
    ds_read_b64_tr_b16 v[254:255], v167 offset:59392
    ds_read_b64_tr_b16 v[224:225], v18 offset:0
    v_mfma_f32_16x16x32_bf16 v[144:147], v[228:231], v[200:203], v[144:147]
    ds_read_b64_tr_b16 v[226:227], v18 offset:2048
    ds_read_b64_tr_b16 v[228:229], v18 offset:8192
    v_mfma_f32_16x16x32_bf16 v[144:147], v[232:235], v[208:211], v[144:147]
    ds_read_b64_tr_b16 v[230:231], v18 offset:10240
    ds_read_b64_tr_b16 v[232:233], v166 offset:0
    s_waitcnt lgkmcnt(7)
    v_mfma_f32_16x16x32_bf16 v[144:147], v[236:239], v[216:219], v[144:147]
    ds_read_b64_tr_b16 v[234:235], v166 offset:2048
    ds_read_b64_tr_b16 v[236:237], v166 offset:8192
    v_mfma_f32_16x16x32_bf16 v[148:151], v[240:243], v[192:195], v[148:151]
    ds_read_b64_tr_b16 v[238:239], v166 offset:10240
    ds_read_b64_tr_b16 v[240:241], v19 offset:0
    v_mfma_f32_16x16x32_bf16 v[148:151], v[244:247], v[200:203], v[148:151]
    ds_read_b64_tr_b16 v[242:243], v19 offset:2048
    ds_read_b64_tr_b16 v[244:245], v19 offset:8192
    v_mfma_f32_16x16x32_bf16 v[148:151], v[248:251], v[208:211], v[148:151]
    ds_read_b64_tr_b16 v[246:247], v19 offset:10240
    ds_read_b64_tr_b16 v[248:249], v167 offset:0
    s_waitcnt lgkmcnt(7)
    v_mfma_f32_16x16x32_bf16 v[148:151], v[252:255], v[216:219], v[148:151]
    ds_read_b64_tr_b16 v[250:251], v167 offset:2048
    ds_read_b64_tr_b16 v[252:253], v167 offset:8192
    v_mfma_f32_16x16x32_bf16 v[152:155], v[224:227], v[36:39], v[152:155]
    ds_read_b64_tr_b16 v[254:255], v167 offset:10240
    ds_read_b64_tr_b16 v[224:225], v18 offset:16384
    v_mfma_f32_16x16x32_bf16 v[152:155], v[228:231], v[44:47], v[152:155]
    ds_read_b64_tr_b16 v[226:227], v18 offset:18432
    ds_read_b64_tr_b16 v[228:229], v18 offset:24576
    v_cvt_pk_bf16_f32 v4, v144, v145
    v_cvt_pk_bf16_f32 v5, v146, v147
    v_cvt_pk_bf16_f32 v6, v148, v149
    v_mfma_f32_16x16x32_bf16 v[152:155], v[232:235], v[52:55], v[152:155]
    ds_read_b64_tr_b16 v[230:231], v18 offset:26624
    ds_read_b64_tr_b16 v[232:233], v166 offset:16384
    v_cvt_pk_bf16_f32 v7, v150, v151
    buffer_store_dwordx4 v[4:7], v24, s[28:31], s58 offen sc1
    s_waitcnt lgkmcnt(7)
    v_mfma_f32_16x16x32_bf16 v[152:155], v[236:239], v[60:63], v[152:155]
    ds_read_b64_tr_b16 v[234:235], v166 offset:18432
    ds_read_b64_tr_b16 v[236:237], v166 offset:24576
    v_mfma_f32_16x16x32_bf16 v[156:159], v[240:243], v[36:39], v[156:159]
    ds_read_b64_tr_b16 v[238:239], v166 offset:26624
    ds_read_b64_tr_b16 v[240:241], v19 offset:16384
    v_mfma_f32_16x16x32_bf16 v[156:159], v[244:247], v[44:47], v[156:159]
    ds_read_b64_tr_b16 v[242:243], v19 offset:18432
    ds_read_b64_tr_b16 v[244:245], v19 offset:24576
    v_mfma_f32_16x16x32_bf16 v[156:159], v[248:251], v[52:55], v[156:159]
    ds_read_b64_tr_b16 v[246:247], v19 offset:26624
    ds_read_b64_tr_b16 v[248:249], v167 offset:16384
    s_waitcnt lgkmcnt(7)
    v_mfma_f32_16x16x32_bf16 v[156:159], v[252:255], v[60:63], v[156:159]
    ds_read_b64_tr_b16 v[250:251], v167 offset:18432
    ds_read_b64_tr_b16 v[252:253], v167 offset:24576
    v_mfma_f32_16x16x32_bf16 v[152:155], v[224:227], v[68:71], v[152:155]
    ds_read_b64_tr_b16 v[254:255], v167 offset:26624
    ds_read_b64_tr_b16 v[224:225], v166 offset:32768
    v_mfma_f32_16x16x32_bf16 v[152:155], v[228:231], v[76:79], v[152:155]
    ds_read_b64_tr_b16 v[226:227], v166 offset:34816
    ds_read_b64_tr_b16 v[228:229], v166 offset:40960
    v_mfma_f32_16x16x32_bf16 v[152:155], v[232:235], v[84:87], v[152:155]
    ds_read_b64_tr_b16 v[230:231], v166 offset:43008
    ds_read_b64_tr_b16 v[232:233], v166 offset:49152
    v_mov_b32 v23, 1
    s_mov_b64 exec, 0xfe
    v_mov_b32 v23, 0
    buffer_atomic_or v23, v28, s[28:31], s64 offen offset:0 sc0 sc1
    s_mov_b64 exec, -1
    s_waitcnt lgkmcnt(7)
    v_mfma_f32_16x16x32_bf16 v[152:155], v[236:239], v[92:95], v[152:155]
    ds_read_b64_tr_b16 v[234:235], v166 offset:51200
    ds_read_b64_tr_b16 v[236:237], v166 offset:57344
    v_mfma_f32_16x16x32_bf16 v[156:159], v[240:243], v[68:71], v[156:159]
    ds_read_b64_tr_b16 v[238:239], v166 offset:59392
    ds_read_b64_tr_b16 v[240:241], v167 offset:32768
    v_mfma_f32_16x16x32_bf16 v[156:159], v[244:247], v[76:79], v[156:159]
    ds_read_b64_tr_b16 v[242:243], v167 offset:34816
    ds_read_b64_tr_b16 v[244:245], v167 offset:40960
    v_mfma_f32_16x16x32_bf16 v[156:159], v[248:251], v[84:87], v[156:159]
    ds_read_b64_tr_b16 v[246:247], v167 offset:43008
    ds_read_b64_tr_b16 v[248:249], v167 offset:49152
    s_waitcnt lgkmcnt(7)
    v_mfma_f32_16x16x32_bf16 v[156:159], v[252:255], v[92:95], v[156:159]
    ds_read_b64_tr_b16 v[250:251], v167 offset:51200
    ds_read_b64_tr_b16 v[252:253], v167 offset:57344
    v_mfma_f32_16x16x32_bf16 v[152:155], v[224:227], v[196:199], v[152:155]
    ds_read_b64_tr_b16 v[254:255], v167 offset:59392
    v_mfma_f32_16x16x32_bf16 v[152:155], v[228:231], v[204:207], v[152:155]
    v_mfma_f32_16x16x32_bf16 v[152:155], v[232:235], v[212:215], v[152:155]
    s_waitcnt lgkmcnt(8)
    v_mfma_f32_16x16x32_bf16 v[152:155], v[236:239], v[220:223], v[152:155]
    s_waitcnt lgkmcnt(6)
    v_mfma_f32_16x16x32_bf16 v[156:159], v[240:243], v[196:199], v[156:159]
    s_waitcnt lgkmcnt(4)
    v_mfma_f32_16x16x32_bf16 v[156:159], v[244:247], v[204:207], v[156:159]
    s_waitcnt lgkmcnt(2)
    v_mfma_f32_16x16x32_bf16 v[156:159], v[248:251], v[212:215], v[156:159]
    s_waitcnt lgkmcnt(0)
    v_mfma_f32_16x16x32_bf16 v[156:159], v[252:255], v[220:223], v[156:159]
    s_waitcnt vmcnt(1)
    s_mov_b64 exec, 112
    global_atomic_or v26, v30, s[18:19] sc1
    s_add_u32 s26, s59, 4096
    s_mov_b32 s27, 0xffff0000
    s_mov_b64 exec, -1
    s_waitcnt vmcnt(1)
    v_cmp_ne_u32 vcc, 1, v23
    s_nop 1
    s_and_b32 s69, vcc_lo, 240
    s_cbranch_scc0 L_poll2a_x
    s_mov_b64 exec, 0xfe
    s_mov_b32 s50, 0
    v_mov_b32 v20, 0
    buffer_atomic_or v20, v28, s[28:31], s64 offen offset:0 sc0 sc1
L_poll2a:
    v_mov_b32 v21, 0
    buffer_atomic_or v21, v28, s[28:31], s64 offen offset:0 sc0 sc1
    s_waitcnt vmcnt(1)
    v_cmp_ne_u32 vcc, 1, v20
    s_nop 1
    s_and_b32 s69, vcc_lo, 240
    s_cbranch_scc0 L_poll2a_x
    v_mov_b32 v20, 0
    buffer_atomic_or v20, v28, s[28:31], s64 offen offset:0 sc0 sc1
    s_waitcnt vmcnt(1)
    v_cmp_ne_u32 vcc, 1, v21
    s_nop 1
    s_and_b32 s69, vcc_lo, 240
    s_cbranch_scc0 L_poll2a_x
    s_add_u32 s50, s50, 1
    s_cmp_lt_u32 s50, 0x20000
    s_cbranch_scc1 L_poll2a
L_poll2a_x:
    s_mov_b64 exec, -1
    buffer_load_dwordx4 v[60:63], v24, s[28:31], s26 offen offset:3072 sc1
    buffer_load_dwordx4 v[56:59], v24, s[28:31], s26 offen offset:2048 sc1
    buffer_load_dwordx4 v[52:55], v24, s[28:31], s26 offen offset:1024 sc1
    buffer_load_dwordx4 v[48:51], v24, s[28:31], s26 offen offset:0 sc1
    s_cbranch_vccz L_poll2_x
    s_mov_b64 exec, 14
    s_mov_b32 s50, 0
    s_waitcnt vmcnt(4)
    v_mov_b32 v20, 0
    buffer_atomic_or v20, v28, s[28:31], s64 offen offset:0 sc0 sc1
L_poll2:
    v_mov_b32 v21, 0
    buffer_atomic_or v21, v28, s[28:31], s64 offen offset:0 sc0 sc1
    s_waitcnt vmcnt(1)
    v_cmp_ne_u32 vcc, 1, v20
    s_nop 1
    s_cbranch_vccz L_poll2_x
    v_mov_b32 v20, 0
    buffer_atomic_or v20, v28, s[28:31], s64 offen offset:0 sc0 sc1
    s_waitcnt vmcnt(1)
    v_cmp_ne_u32 vcc, 1, v21
    s_nop 1
    s_cbranch_vccz L_poll2_x
    s_add_u32 s50, s50, 1
    s_cmp_lt_u32 s50, 0x20000
    s_cbranch_scc1 L_poll2
L_poll2_x:
    s_mov_b64 exec, -1
    buffer_load_dwordx4 v[44:47], v24, s[28:31], s59 offen offset:3072 sc1
    buffer_load_dwordx4 v[40:43], v24, s[28:31], s59 offen offset:2048 sc1
    buffer_load_dwordx4 v[36:39], v24, s[28:31], s59 offen offset:1024 sc1
    s_waitcnt vmcnt(6)
    v_lshlrev_b32 v2, 16, v60
    v_and_b32 v3, s27, v60
    v_pk_add_f32 v[152:153], v[152:153], v[2:3]
    v_lshlrev_b32 v2, 16, v61
    v_and_b32 v3, s27, v61
    v_pk_add_f32 v[154:155], v[154:155], v[2:3]
    v_lshlrev_b32 v2, 16, v62
    v_and_b32 v3, s27, v62
    v_pk_add_f32 v[156:157], v[156:157], v[2:3]
    v_lshlrev_b32 v2, 16, v63
    v_and_b32 v3, s27, v63
    v_pk_add_f32 v[158:159], v[158:159], v[2:3]
    s_waitcnt vmcnt(5)
    v_lshlrev_b32 v2, 16, v56
    v_and_b32 v3, s27, v56
    v_pk_add_f32 v[152:153], v[152:153], v[2:3]
    v_lshlrev_b32 v2, 16, v57
    v_and_b32 v3, s27, v57
    v_pk_add_f32 v[154:155], v[154:155], v[2:3]
    v_lshlrev_b32 v2, 16, v58
    v_and_b32 v3, s27, v58
    v_pk_add_f32 v[156:157], v[156:157], v[2:3]
    v_lshlrev_b32 v2, 16, v59
    v_and_b32 v3, s27, v59
    v_pk_add_f32 v[158:159], v[158:159], v[2:3]
    s_waitcnt vmcnt(4)
    v_lshlrev_b32 v2, 16, v52
    v_and_b32 v3, s27, v52
    v_pk_add_f32 v[152:153], v[152:153], v[2:3]
    v_lshlrev_b32 v2, 16, v53
    v_and_b32 v3, s27, v53
    v_pk_add_f32 v[154:155], v[154:155], v[2:3]
    v_lshlrev_b32 v2, 16, v54
    v_and_b32 v3, s27, v54
    v_pk_add_f32 v[156:157], v[156:157], v[2:3]
    v_lshlrev_b32 v2, 16, v55
    v_and_b32 v3, s27, v55
    v_pk_add_f32 v[158:159], v[158:159], v[2:3]
    s_waitcnt vmcnt(3)
    v_lshlrev_b32 v2, 16, v48
    v_and_b32 v3, s27, v48
    v_pk_add_f32 v[152:153], v[152:153], v[2:3]
    v_lshlrev_b32 v2, 16, v49
    v_and_b32 v3, s27, v49
    v_pk_add_f32 v[154:155], v[154:155], v[2:3]
    v_lshlrev_b32 v2, 16, v50
    v_and_b32 v3, s27, v50
    v_pk_add_f32 v[156:157], v[156:157], v[2:3]
    v_lshlrev_b32 v2, 16, v51
    v_and_b32 v3, s27, v51
    v_pk_add_f32 v[158:159], v[158:159], v[2:3]
    s_waitcnt vmcnt(2)
    v_lshlrev_b32 v2, 16, v44
    v_and_b32 v3, s27, v44
    v_pk_add_f32 v[152:153], v[152:153], v[2:3]
    v_lshlrev_b32 v2, 16, v45
    v_and_b32 v3, s27, v45
    v_pk_add_f32 v[154:155], v[154:155], v[2:3]
    v_lshlrev_b32 v2, 16, v46
    v_and_b32 v3, s27, v46
    v_pk_add_f32 v[156:157], v[156:157], v[2:3]
    v_lshlrev_b32 v2, 16, v47
    v_and_b32 v3, s27, v47
    v_pk_add_f32 v[158:159], v[158:159], v[2:3]
    s_waitcnt vmcnt(1)
    v_lshlrev_b32 v2, 16, v40
    v_and_b32 v3, s27, v40
    v_pk_add_f32 v[152:153], v[152:153], v[2:3]
    v_lshlrev_b32 v2, 16, v41
    v_and_b32 v3, s27, v41
    v_pk_add_f32 v[154:155], v[154:155], v[2:3]
    v_lshlrev_b32 v2, 16, v42
    v_and_b32 v3, s27, v42
    v_pk_add_f32 v[156:157], v[156:157], v[2:3]
    v_lshlrev_b32 v2, 16, v43
    v_and_b32 v3, s27, v43
    v_pk_add_f32 v[158:159], v[158:159], v[2:3]
    s_waitcnt vmcnt(0)
    v_lshlrev_b32 v2, 16, v36
    v_and_b32 v3, s27, v36
    v_pk_add_f32 v[152:153], v[152:153], v[2:3]
    v_lshlrev_b32 v2, 16, v37
    v_and_b32 v3, s27, v37
    v_pk_add_f32 v[154:155], v[154:155], v[2:3]
    v_lshlrev_b32 v2, 16, v38
    v_and_b32 v3, s27, v38
    v_pk_add_f32 v[156:157], v[156:157], v[2:3]
    v_lshlrev_b32 v2, 16, v39
    v_and_b32 v3, s27, v39
    v_pk_add_f32 v[158:159], v[158:159], v[2:3]
    v_cvt_pk_bf16_f32 v4, v152, v153
    v_cvt_pk_bf16_f32 v5, v154, v155
    v_cvt_pk_bf16_f32 v6, v156, v157
    v_cvt_pk_bf16_f32 v7, v158, v159
    s_nop 0
    v_permlane16_swap_b32 v4, v6
    v_permlane16_swap_b32 v5, v7
    buffer_store_dwordx4 v[4:7], v29, s[32:35], 0 offen sc1
L_end:
    s_endpgm
L_ini:
    global_load_dword v21, v31, s[16:17] sc1
    s_waitcnt vmcnt(0)
    v_cmp_eq_u32 vcc, 0, v21
    s_add_u32 s70, s70, 0x4000
    s_cbranch_scc1 L_ini_ok
    s_cbranch_vccnz L_ini
    s_branch L_ini_ok
L_pb:
    s_mov_b64 exec, 14
    v_mov_b32 v22, 0
    buffer_atomic_or v22, v27, s[28:31], s64 offen offset:144 sc0 sc1
    s_mov_b64 exec, -1
    s_waitcnt vmcnt(0)
    v_cmp_ne_u32 vcc, 1, v22
    s_add_u32 s70, s70, 0x4000
    s_cbranch_scc1 L_pb_ok
    s_cbranch_vccnz L_pb
    s_branch L_pb_ok
.fill (32768 - (. - standalone__mha_block_cached__near_ridge_kernel)) / 4, 4, 0xbf810000
.section .rodata,"a"
.p2align 6
.amdhsa_kernel standalone__mha_block_cached__near_ridge_kernel
  .amdhsa_next_free_vgpr 256
  .amdhsa_next_free_sgpr 102
  .amdhsa_accum_offset 256
  .amdhsa_float_denorm_mode_32 3
  .amdhsa_group_segment_fixed_size 0
  .amdhsa_kernarg_size 64
  .amdhsa_user_sgpr_count 2
  .amdhsa_user_sgpr_kernarg_segment_ptr 1
  .amdhsa_system_sgpr_workgroup_id_x 1
.end_amdhsa_kernel
```
